```python
import torch

def _softmax(x, axis=-1):
    return torch.softmax(x, dim=axis)
def _gelu(x):
    return torch.nn.functional.gelu(x, approximate="tanh")
def _silu(x):
    return torch.nn.functional.silu(x)
def _sigmoid(x):
    return torch.sigmoid(x)
def _layernorm(x, axis=-1, eps=1e-5):
    m = x.mean(dim=axis, keepdim=True)
    v = x.var(dim=axis, keepdim=True, unbiased=False)
    return (x - m) / torch.sqrt(v + eps)
def _scatter_add(tgt, idx, src, axis=0):
    return tgt.clone().index_add_(axis, idx, src)
def _segment_sum(src, seg, n):
    out = torch.zeros((n,) + src.shape[1:], dtype=src.dtype)
    return out.index_add_(0, seg, src)
def _pad(x, pw):
    flat = tuple(v for pair in reversed(pw) for v in pair)
    return torch.nn.functional.pad(x, flat)

kernel_name = 'standalone__deep_cross_pnn__recsys'

def setup_inputs():

    _w = (lambda a: (lambda t: t.to(torch.bfloat16) if t.is_floating_point() else t)(torch.as_tensor(a)))
    B, F, D, V = 1024, 100, 128, min(1000, 100000)
    H = 4 * D
    return {
        "idx": _w((lambda lo, hi, *s: torch.randint(lo, hi, s))(0, V, B, F).to(torch.int64)),
        "table": _w((lambda *s: torch.randn(*s, dtype=torch.bfloat16) * 3.2)(V, D) * (D ** -0.5)),
        "w_p": _w((lambda *s: torch.randn(*s, dtype=torch.bfloat16) * 0.1)(F * F) * ((F * F) ** -0.5)),
        "w1": _w((lambda *s: torch.randn(*s, dtype=torch.bfloat16) * 3.2)(F * D, H) * ((F * D) ** -0.5)),
        "b1": _w((lambda *s: torch.randn(*s, dtype=torch.bfloat16) * 3.2)(H) * 0.01),
        "w2": _w((lambda *s: torch.randn(*s, dtype=torch.bfloat16) * 0.1)(H) * (H ** -0.5)),
        "b2": _w((lambda *s: torch.randn(*s, dtype=torch.bfloat16) * 0.1)(1) * 0.01),
    }

def reference(idx, table, w_p, w1, b1, w2, b2):
    emb = table[idx]
    B = emb.shape[0]; F = emb.shape[1]; D = emb.shape[2]
    ip = torch.einsum('bid,bjd->bij', emb, emb)
    ip = ip.reshape(B, F * F)
    logit_p = ip @ w_p
    z = emb.reshape(B, F * D)
    h = _gelu(z @ w1 + b1)
    logit_d = h @ w2 + b2
    return logit_p + logit_d
```

```asm
; @launch grid=(256,1,1) block=(256,1,1) lds=160384
.amdgcn_target "amdgcn-amd-amdhsa--gfx950"
.text
.globl standalone__deep_cross_pnn__recsys_kernel
.p2align 12
.p2align 8
.type standalone__deep_cross_pnn__recsys_kernel,@function
standalone__deep_cross_pnn__recsys_kernel:
    s_cmp_ge_u32 s2, 256
    s_cbranch_scc1 L_done
    s_xor_b32 s2, s2, 3
    s_load_dwordx16 s[44:59], s[0:1], 0
    s_load_dwordx2 s[36:37], s[0:1], 72
    s_getpc_b64 s[90:91]
L_pc:
    s_lshr_b32 s92, s2, 3
    s_lshl_b32 s92, s92, 10
    v_lshl_add_u32 v6, v0, 2, s92
    v_min_u32 v6, L_end-L_pc-4, v6
    global_load_dword v240, v6, s[90:91]
    v_lshrrev_b32 v6, 6, v0
    v_and_b32 v1, 63, v0
    s_bfe_u32 s16, s2, 0x20003
    v_readfirstlane_b32 s89, v6
    s_lshr_b32 s17, s2, 5
    v_lshlrev_b32 v5, 4, v1
    s_lshr_b32 s96, s2, 6
    s_mul_i32 s92, s89, 3072
    s_mul_i32 s93, s17, 51200
    s_add_u32 s87, s92, 66560
    s_add_u32 s93, s93, s92
    v_add_u32 v8, s93, v5
    s_and_b32 s21, s89, 1
    s_lshl_b32 s21, s21, 10
    s_sub_u32 s21, s21, s92
    s_add_u32 s21, s21, 49152
    s_mov_b32 s26, 409600
    s_mov_b32 s27, 0x20000
    s_mov_b32 s30, 259264
    s_mov_b32 s31, 0x20000
    s_mov_b32 s34, 13107200
    s_mov_b32 s35, 0x20000
    v_and_b32 v7, 3, v1
    v_xor_b32 v7, s96, v7
    v_lshrrev_b32 v6, 2, v1
    v_lshlrev_b32 v6, 10, v6
    v_lshl_add_u32 v6, v7, 4, v6
    s_and_b32 s92, s16, 1
    s_lshl1_add_u32 s92, s17, s92
    s_lshl2_add_u32 s85, s89, s16
    s_lshl_b32 s93, s92, 8
    s_add_u32 s85, s85, s93
    s_lshl_b32 s85, s85, 6
    s_add_u32 s85, s85, 3264
    s_mul_i32 s86, s89, 16400
    s_lshl2_add_u32 s86, s93, s86
    s_and_b32 s15, s2, 7
    v_and_b32 v2, 0x70, v5
    v_and_b32 v7, 8, v1
    v_lshl_add_u32 v2, v7, 7, v2
    v_and_b32 v7, 48, v1
    v_lshl_add_u32 v250, v7, 13, v2
    v_mul_u32_u24 v7, 49152, v7
    v_add_u32 v2, v7, v2
    v_add_u32 v3, 0x1000, v2
    s_lshl_b32 s92, s16, 8
    s_add_u32 s92, s92, s15
    s_lshl_b32 s95, s92, 7
    s_mul_i32 s94, s89, 24
    s_and_b32 s93, s17, 1
    s_add_u32 s94, s94, s93
    s_lshl4_add_u32 s94, s94, s96
    s_lshl_b32 s94, s94, 13
    s_add_u32 s60, s95, s94
    s_xor_b32 s61, s60, 8192
    s_xor_b32 s62, s60, 16384
    s_xor_b32 s63, s60, 24576
    s_xor_b32 s64, s60, 131072
    s_xor_b32 s65, s60, 139264
    s_xor_b32 s66, s60, 147456
    s_xor_b32 s67, s60, 155648
    s_add_u32 s68, s60, 262144
    s_xor_b32 s69, s68, 8192
    s_xor_b32 s70, s68, 16384
    s_xor_b32 s71, s68, 24576
    s_xor_b32 s72, s68, 131072
    s_xor_b32 s73, s68, 139264
    s_xor_b32 s74, s68, 147456
    s_xor_b32 s75, s68, 155648
    s_add_u32 s76, s68, 262144
    s_xor_b32 s77, s76, 8192
    s_xor_b32 s78, s76, 16384
    s_xor_b32 s79, s76, 24576
    s_xor_b32 s80, s76, 131072
    s_xor_b32 s81, s76, 139264
    s_xor_b32 s82, s76, 147456
    s_xor_b32 s83, s76, 155648
    s_xor_b32 s94, s89, s96
    s_lshl_b32 s94, s94, 13
    s_add_u32 s95, s95, s94
    s_add_u32 s84, s95, 12582912
    v_add_u32 v251, 0x1000, v250
    s_movk_i32 s18, 0x4010
    s_mov_b32 s38, 4327424
    s_mov_b32 s39, 0x20000
    s_mov_b32 s42, 20000
    s_mov_b32 s43, 0x20000
    s_mov_b32 vcc_lo, 0x00ff00ff
    s_mov_b32 vcc_hi, 0x00ff00ff
    v_mov_b32 v4, 0x03020706
    v_mov_b32 v7, 0x05040100
    v_cndmask_b32 v4, v4, v7, vcc
    s_lshl2_add_u32 s8, s2, s89
    s_lshl_b32 s91, s8, 12
    v_and_b32 v7, 15, v1
    v_mul_u32_u24 v7, 400, v7
    v_lshrrev_b32 v9, 4, v1
    v_add_u32 v7, 66560, v7
    v_lshl_add_u32 v10, v9, 2, v7
    v_mad_u32_u24 v7, v9, 24, v7
    s_mul_i32 s92, s89, 96
    v_add_u32 v7, s92, v7
    s_xor_b32 s93, s89, 3
    s_mul_i32 s93, s93, 12800
    v_add_u32 v16, s93, v7
    v_add_u32 v20, s93, v10
    s_xor_b32 s93, s89, 2
    s_mul_i32 s93, s93, 12800
    v_add_u32 v17, s93, v7
    v_add_u32 v21, s93, v10
    s_xor_b32 s93, s89, 1
    s_mul_i32 s93, s93, 12800
    v_add_u32 v18, s93, v7
    v_add_u32 v22, s93, v10
    s_mul_i32 s93, s89, 12800
    v_add_u32 v19, s93, v7
    v_add_u32 v23, s93, v10
    s_waitcnt lgkmcnt(0)
    s_sub_u32 s28, s46, 3264
    s_subb_u32 s29, s47, 0
    s_mov_b64 s[24:25], s[44:45]
    s_mov_b64 s[32:33], s[50:51]
    s_mul_i32 s88, s16, 12288
    s_add_u32 m0, s88, s87
    s_nop 0
    buffer_load_dwordx4 v8, s[24:27], s88 offen offset:0 lds
    buffer_load_dwordx4 v8, s[24:27], s88 offen offset:1024 lds
    buffer_load_dwordx4 v8, s[24:27], s88 offen offset:2048 lds
    s_add_u32 m0, s21, s87
    s_nop 0
    buffer_load_dwordx4 v8, s[24:27], s21 offen offset:0 lds
    s_xor_b32 m0, s86, 0
    s_xor_b32 s88, s85, 0
    buffer_load_dwordx4 v6, s[28:31], s88 offen lds
    buffer_load_dwordx4 v[144:147], v2, s[32:35], s60 offen offset:0
    buffer_load_dwordx4 v[148:151], v2, s[32:35], s60 offen offset:2048
    buffer_load_dwordx4 v[152:155], v3, s[32:35], s60 offen offset:0
    buffer_load_dwordx4 v[156:159], v3, s[32:35], s60 offen offset:2048
    s_mov_b64 s[40:41], s[48:49]
    s_mov_b32 s12, 0x7fa57fa5
    s_andn2_b32 s47, s2, 7
    s_lshl1_add_u32 s47, s47, s15
    s_mul_i32 s8, s89, 33
    s_and_b32 s8, s8, 0x22
    s_lshl2_add_u32 s8, s47, s8
    s_mul_i32 s47, s8, 200
    s_lshl_b32 s6, s89, 10
    s_add_u32 s6, s6, 122176
    v_lshrrev_b32 v7, 4, v1
    v_lshl_add_u32 v141, v7, 4, s6
    v_lshl_add_u32 v142, v7, 2, s6
    v_sub_u32 v7, 0, v7
    v_and_b32 v7, 3, v7
    v_and_b32 v245, 15, v1
    v_xor_b32 v7, v7, v245
    v_lshlrev_b32 v11, 4, v7
    s_movk_i32 s44, 3264
    s_movk_i32 s45, 2176
    s_movk_i32 s46, 1088
    s_mul_i32 s4, s89, 5120
    s_add_u32 s5, s4, 131072
    s_mul_i32 s3, s89, 4352
    s_add_u32 s3, s3, 65600
    s_mul_i32 s50, s89, 1088
    s_add_u32 s50, s50, 155776
    v_lshrrev_b32 v245, 4, v1
    v_bfe_u32 v7, v1, 2, 2
    v_sub_u32 v246, 0, v7
    v_xor_b32 v246, v246, v245
    v_and_b32 v246, 3, v246
    v_lshl_add_u32 v246, v7, 4, v246
    v_and_b32 v7, 3, v1
    v_mad_u32_u24 v246, v7, 64, v246
    v_lshl_add_u32 v246, v7, 2, v246
    v_lshl_add_u32 v143, v246, 4, s3
    v_sub_u32 v246, 0, v7
    v_xor_b32 v246, v246, v245
    v_and_b32 v246, 3, v246
    v_lshl_add_u32 v246, v7, 4, v246
    v_lshl_add_u32 v246, v246, 4, s50
    v_mov_b32 v7, 151568
    s_mov_b32 s22, 0x000f000f
    s_mov_b32 s23, 0x000f000f
    v_cndmask_b32_e64 v140, v7, v246, s[22:23]
    v_and_b32 v7, 7, v1
    s_lshl_b32 s92, s89, 6
    s_add_u32 s92, s92, 160128
    v_lshl_add_u32 v252, v7, 3, s92
    s_lshl4_add_u32 s92, s89, 160128
    v_lshrrev_b32 v245, 4, v1
    v_and_b32 v246, 12, v1
    v_lshl_add_u32 v246, v246, 2, v245
    v_lshl_add_u32 v254, v246, 2, s92
    s_lshl_b32 s93, s89, 8
    s_add_u32 s93, s93, 153600
    v_mul_u32_u24 v245, 9, v245
    v_and_b32 v245, 0x11, v245
    v_lshl_add_u32 v7, v7, 1, v245
    v_lshl_add_u32 v253, v7, 3, s93
    v_mul_u32_u24 v7, 0x4104, v1
    v_and_b32 v248, 0x1c8c0, v7
    s_mov_b32 s9, 0xbdd2d3e8
    s_mov_b32 s10, 0xc0135761
    s_mov_b32 s11, 0xffff0000
    s_mov_b32 s13, 0x3f80
    s_xor_b32 s88, s16, 1
    s_mul_i32 s88, s88, 12288
    s_add_u32 m0, s88, s87
    s_nop 0
    buffer_load_dwordx4 v8, s[24:27], s88 offen offset:0 lds
    buffer_load_dwordx4 v8, s[24:27], s88 offen offset:1024 lds
    buffer_load_dwordx4 v8, s[24:27], s88 offen offset:2048 lds
    s_xor_b32 s88, s16, 2
    s_mul_i32 s88, s88, 12288
    s_add_u32 m0, s88, s87
    s_nop 0
    buffer_load_dwordx4 v8, s[24:27], s88 offen offset:0 lds
    buffer_load_dwordx4 v8, s[24:27], s88 offen offset:1024 lds
    buffer_load_dwordx4 v8, s[24:27], s88 offen offset:2048 lds
    s_xor_b32 s88, s16, 3
    s_mul_i32 s88, s88, 12288
    s_add_u32 m0, s88, s87
    s_nop 0
    buffer_load_dwordx4 v8, s[24:27], s88 offen offset:0 lds
    buffer_load_dwordx4 v8, s[24:27], s88 offen offset:1024 lds
    buffer_load_dwordx4 v8, s[24:27], s88 offen offset:2048 lds
    v_accvgpr_write_b32 a244, 0
    v_accvgpr_write_b32 a245, 0
    v_accvgpr_write_b32 a246, 0
    v_accvgpr_write_b32 a247, 0
    v_add_u32 v245, 151552, v5
    ds_write_b128 v245, a[244:247]
    ds_write_b128 v245, a[244:247] offset:1024
    v_and_b32 v7, 16, v5
    v_lshlrev_b32 v0, v7, s13
    s_mov_b32 s48, 0x00300003
    s_mov_b32 s49, 0x30000300
    v_and_b32 v245, 15, v1
    v_mul_u32_u24 v245, 200, v245
    v_lshrrev_b32 v246, 4, v1
    v_lshl_add_u32 v246, v246, 3, v245
    v_add_u32 v255, 131072, v246
    s_add_u32 s51, s4, 3072
    s_mov_b64 exec, 0
    s_branch L_pg1
L_pgb:
    s_mov_b64 exec, -1
    s_waitcnt vmcnt(12)
    v_mov_b32_dpp v12, v144 row_ror:8 row_mask:0xf bank_mask:0xf
    v_mov_b32_dpp v13, v145 row_ror:8 row_mask:0xf bank_mask:0xf
    v_perm_b32 v48, v12, v144, v4
    v_perm_b32 v52, v13, v145, v4
    v_mov_b32_dpp v14, v146 row_ror:8 row_mask:0xf bank_mask:0xf
    v_mov_b32_dpp v15, v147 row_ror:8 row_mask:0xf bank_mask:0xf
    v_perm_b32 v56, v14, v146, v4
    v_perm_b32 v60, v15, v147, v4
    s_waitcnt vmcnt(11)
    v_mov_b32_dpp v12, v148 row_ror:8 row_mask:0xf bank_mask:0xf
    v_mov_b32_dpp v13, v149 row_ror:8 row_mask:0xf bank_mask:0xf
    v_perm_b32 v49, v12, v148, v4
    v_perm_b32 v53, v13, v149, v4
    v_mov_b32_dpp v14, v150 row_ror:8 row_mask:0xf bank_mask:0xf
    v_mov_b32_dpp v15, v151 row_ror:8 row_mask:0xf bank_mask:0xf
    v_perm_b32 v57, v14, v150, v4
    v_perm_b32 v61, v15, v151, v4
    s_waitcnt vmcnt(10)
    v_mov_b32_dpp v12, v152 row_ror:8 row_mask:0xf bank_mask:0xf
    v_mov_b32_dpp v13, v153 row_ror:8 row_mask:0xf bank_mask:0xf
    v_perm_b32 v50, v12, v152, v4
    v_perm_b32 v54, v13, v153, v4
    v_mov_b32_dpp v14, v154 row_ror:8 row_mask:0xf bank_mask:0xf
    v_mov_b32_dpp v15, v155 row_ror:8 row_mask:0xf bank_mask:0xf
    v_perm_b32 v58, v14, v154, v4
    v_perm_b32 v62, v15, v155, v4
    s_waitcnt vmcnt(9)
    v_mov_b32_dpp v12, v156 row_ror:8 row_mask:0xf bank_mask:0xf
    v_mov_b32_dpp v13, v157 row_ror:8 row_mask:0xf bank_mask:0xf
    v_perm_b32 v51, v12, v156, v4
    v_perm_b32 v55, v13, v157, v4
    v_mov_b32_dpp v14, v158 row_ror:8 row_mask:0xf bank_mask:0xf
    v_mov_b32_dpp v15, v159 row_ror:8 row_mask:0xf bank_mask:0xf
    v_perm_b32 v59, v14, v158, v4
    v_perm_b32 v63, v15, v159, v4
    s_xor_b32 m0, s86, 1024
    s_xor_b32 s88, s85, 16384
    buffer_load_dwordx4 v6, s[28:31], s88 offen lds
    s_xor_b32 m0, s86, 2048
    s_xor_b32 s88, s85, 32768
    buffer_load_dwordx4 v6, s[28:31], s88 offen lds
    s_xor_b32 m0, s86, 3072
    s_xor_b32 s88, s85, 49152
    buffer_load_dwordx4 v6, s[28:31], s88 offen lds
    s_xor_b32 m0, s86, 4096
    s_xor_b32 s88, s85, 65536
    buffer_load_dwordx4 v6, s[28:31], s88 offen lds
    s_xor_b32 m0, s86, 5120
    s_xor_b32 s88, s85, 81920
    buffer_load_dwordx4 v6, s[28:31], s88 offen lds
    s_xor_b32 m0, s86, 6144
    s_xor_b32 s88, s85, 98304
    buffer_load_dwordx4 v6, s[28:31], s88 offen lds
    s_xor_b32 m0, s86, 7168
    s_xor_b32 s88, s85, 114688
    buffer_load_dwordx4 v6, s[28:31], s88 offen lds
    s_xor_b32 m0, s86, 8192
    s_xor_b32 s88, s85, 131072
    buffer_load_dwordx4 v6, s[28:31], s88 offen lds
    s_xor_b32 m0, s86, 9216
    s_xor_b32 s88, s85, 147456
    buffer_load_dwordx4 v6, s[28:31], s88 offen lds
    s_waitcnt vmcnt(9)
    s_barrier
    ds_read_b64 v[192:193], v16 offset:0
    ds_read_b64 v[194:195], v16 offset:8
    ds_read_b64 v[196:197], v16 offset:16
    ds_read_b64 v[198:199], v17 offset:0
    ds_read_b64 v[200:201], v17 offset:8
    ds_read_b64 v[202:203], v17 offset:16
    ds_read_b64 v[204:205], v18 offset:0
    ds_read_b64 v[206:207], v18 offset:8
    ds_read_b64 v[208:209], v18 offset:16
    ds_read_b64 v[210:211], v16 offset:6400
    ds_read_b64 v[212:213], v16 offset:6408
    ds_read_b64 v[214:215], v16 offset:6416
    ds_read_b64 v[216:217], v17 offset:6400
    ds_read_b64 v[218:219], v17 offset:6408
    ds_read_b64 v[220:221], v17 offset:6416
    ds_read_b64 v[222:223], v18 offset:6400
    ds_read_b64 v[224:225], v18 offset:6408
    s_xor_b32 m0, s86, 10240
    s_xor_b32 s88, s85, 163840
    buffer_load_dwordx4 v6, s[28:31], s88 offen lds
    ds_read_b64 v[226:227], v18 offset:6416
    ds_read_b64 v[228:229], v19 offset:0
    ds_read_b64 v[230:231], v19 offset:8
    ds_read_b64 v[232:233], v19 offset:16
    ds_read_b64 v[234:235], v19 offset:6400
    ds_read_b64 v[236:237], v19 offset:6408
    ds_read_b64 v[238:239], v19 offset:6416
    ds_read_b32 v128, v20 offset:384
    ds_read_b32 v129, v21 offset:384
    ds_read_b32 v130, v22 offset:384
    ds_read_b32 v131, v20 offset:6784
    ds_read_b32 v132, v21 offset:6784
    ds_read_b32 v133, v22 offset:6784
    ds_read_b32 v134, v23 offset:384
    ds_read_b32 v135, v23 offset:6784
    s_xor_b32 m0, s86, 11264
    s_xor_b32 s88, s85, 180224
    buffer_load_dwordx4 v6, s[28:31], s88 offen lds
    s_bitcmp1_b32 s2, 5
    s_waitcnt lgkmcnt(8)
    s_cbranch_scc1 L_a1
    v_mul_lo_u16 v80, s18, v192
    v_mul_lo_u16 v81, s18, v198
    v_mul_lo_u16 v82, s18, v204
    v_mul_lo_u16 v83, s18, v210
    v_mul_lo_u16 v84, s18, v216
    v_mul_lo_u16 v85, s18, v222
    v_mul_lo_u16 v86, s18, v228
    v_mul_lo_u16 v87, s18, v234
    v_mul_lo_u16 v88, s18, v193
    v_mul_lo_u16 v89, s18, v199
    v_mul_lo_u16 v90, s18, v205
    v_mul_lo_u16 v91, s18, v211
    v_mul_lo_u16 v92, s18, v217
    v_mul_lo_u16 v93, s18, v223
    v_mul_lo_u16 v94, s18, v229
    v_mul_lo_u16 v95, s18, v235
    v_mul_lo_u16 v96, s18, v194
    v_mul_lo_u16 v97, s18, v200
    v_mul_lo_u16 v98, s18, v206
    v_mul_lo_u16 v99, s18, v212
    v_mul_lo_u16 v100, s18, v218
    v_mul_lo_u16 v101, s18, v224
    v_mul_lo_u16 v102, s18, v230
    v_mul_lo_u16 v103, s18, v236
    v_mul_lo_u16 v104, s18, v195
    v_mul_lo_u16 v105, s18, v201
    v_mul_lo_u16 v106, s18, v207
    v_mul_lo_u16 v107, s18, v213
    v_mul_lo_u16 v108, s18, v219
    v_mul_lo_u16 v109, s18, v225
    v_mul_lo_u16 v110, s18, v231
    v_mul_lo_u16 v111, s18, v237
    v_mul_lo_u16 v112, s18, v196
    v_mul_lo_u16 v113, s18, v202
    v_mul_lo_u16 v114, s18, v208
    v_mul_lo_u16 v115, s18, v214
    v_mul_lo_u16 v116, s18, v220
    v_mul_lo_u16 v117, s18, v226
    v_mul_lo_u16 v118, s18, v232
    v_mul_lo_u16 v119, s18, v238
    v_mul_lo_u16 v120, s18, v197
    v_mul_lo_u16 v121, s18, v203
    v_mul_lo_u16 v122, s18, v209
    v_mul_lo_u16 v123, s18, v215
    v_mul_lo_u16 v124, s18, v221
    v_mul_lo_u16 v125, s18, v227
    v_mul_lo_u16 v126, s18, v233
    v_mul_lo_u16 v127, s18, v239
    s_branch L_a1b
L_a1:
    v_mul_lo_u16 v80, s18, v193
    v_mul_lo_u16 v81, s18, v199
    v_mul_lo_u16 v82, s18, v205
    v_mul_lo_u16 v83, s18, v211
    v_mul_lo_u16 v84, s18, v217
    v_mul_lo_u16 v85, s18, v223
    v_mul_lo_u16 v86, s18, v229
    v_mul_lo_u16 v87, s18, v235
    v_mul_lo_u16 v88, s18, v192
    v_mul_lo_u16 v89, s18, v198
    v_mul_lo_u16 v90, s18, v204
    v_mul_lo_u16 v91, s18, v210
    v_mul_lo_u16 v92, s18, v216
    v_mul_lo_u16 v93, s18, v222
    v_mul_lo_u16 v94, s18, v228
    v_mul_lo_u16 v95, s18, v234
    v_mul_lo_u16 v96, s18, v195
    v_mul_lo_u16 v97, s18, v201
    v_mul_lo_u16 v98, s18, v207
    v_mul_lo_u16 v99, s18, v213
    v_mul_lo_u16 v100, s18, v219
    v_mul_lo_u16 v101, s18, v225
    v_mul_lo_u16 v102, s18, v231
    v_mul_lo_u16 v103, s18, v237
    v_mul_lo_u16 v104, s18, v194
    v_mul_lo_u16 v105, s18, v200
    v_mul_lo_u16 v106, s18, v206
    v_mul_lo_u16 v107, s18, v212
    v_mul_lo_u16 v108, s18, v218
    v_mul_lo_u16 v109, s18, v224
    v_mul_lo_u16 v110, s18, v230
    v_mul_lo_u16 v111, s18, v236
    v_mul_lo_u16 v112, s18, v197
    v_mul_lo_u16 v113, s18, v203
    v_mul_lo_u16 v114, s18, v209
    v_mul_lo_u16 v115, s18, v215
    v_mul_lo_u16 v116, s18, v221
    v_mul_lo_u16 v117, s18, v227
    v_mul_lo_u16 v118, s18, v233
    v_mul_lo_u16 v119, s18, v239
    v_mul_lo_u16 v120, s18, v196
    v_mul_lo_u16 v121, s18, v202
    v_mul_lo_u16 v122, s18, v208
    v_mul_lo_u16 v123, s18, v214
    v_mul_lo_u16 v124, s18, v220
    v_mul_lo_u16 v125, s18, v226
    v_mul_lo_u16 v126, s18, v232
    v_mul_lo_u16 v127, s18, v238
L_a1b:
    s_xor_b32 m0, s86, 12288
    s_xor_b32 s88, s85, 196608
    buffer_load_dwordx4 v6, s[28:31], s88 offen lds
    s_xor_b32 m0, s86, 13312
    s_xor_b32 s88, s85, 212992
    buffer_load_dwordx4 v6, s[28:31], s88 offen lds
    s_xor_b32 m0, s86, 14336
    s_xor_b32 s88, s85, 229376
    buffer_load_dwordx4 v6, s[28:31], s88 offen lds
    s_xor_b32 m0, s86, 15360
    s_xor_b32 s88, s85, 245760
    buffer_load_dwordx4 v6, s[28:31], s88 offen lds
    s_mov_b32 m0, s6
    s_nop 0
    buffer_load_dwordx4 v5, s[24:27], s47 offen lds
    buffer_load_dwordx4 v[160:163], v2, s[32:35], s61 offen offset:0
    buffer_load_dwordx4 v[164:167], v2, s[32:35], s61 offen offset:2048
    buffer_load_dwordx4 v[168:171], v3, s[32:35], s61 offen offset:0
    buffer_load_dwordx4 v[172:175], v3, s[32:35], s61 offen offset:2048
    buffer_load_dwordx4 v[176:179], v2, s[32:35], s62 offen offset:0
    buffer_load_dwordx4 v[180:183], v2, s[32:35], s62 offen offset:2048
    buffer_load_dwordx4 v[184:187], v3, s[32:35], s62 offen offset:0
    buffer_load_dwordx4 v[188:191], v3, s[32:35], s62 offen offset:2048
    s_lshl_b32 s93, s89, 4
    v_mov_b32 v7, s93
    s_waitcnt lgkmcnt(7)
    v_mad_u16 v128, v128, s18, v7
    s_waitcnt lgkmcnt(6)
    v_mad_u16 v129, v129, s18, v7
    s_waitcnt lgkmcnt(5)
    v_mad_u16 v130, v130, s18, v7
    s_waitcnt lgkmcnt(4)
    v_mad_u16 v131, v131, s18, v7
    s_waitcnt lgkmcnt(3)
    v_mad_u16 v132, v132, s18, v7
    s_waitcnt lgkmcnt(2)
    v_mad_u16 v133, v133, s18, v7
    s_waitcnt lgkmcnt(1)
    v_mad_u16 v134, v134, s18, v7
    s_waitcnt lgkmcnt(0)
    v_mad_u16 v135, v135, s18, v7
    v_mov_b32 v244, 0
    s_lshl_b32 s92, s89, 8
    s_add_u32 s92, s92, 65280
    v_and_b32 v246, 1, v1
    v_mul_u32_u24 v246, 8224, v246
    v_and_b32 v245, 2, v1
    v_mul_u32_u24 v245, 8256, v245
    v_add3_u32 v7, v246, v245, s92
    v_and_b32 v246, 0xc0, v5
    v_and_b32 v245, 48, v1
    v_add3_u32 v7, v246, v245, v7
    s_lshl_b32 s92, s89, 10
    s_add_u32 s92, s92, 65536
    v_add_u32 v8, s92, v5
    v_xor_b32 v10, 3072, v8
    v_xor_b32 v245, 2048, v8
    v_xor_b32 v246, 1024, v8
    s_lshl2_add_u32 s92, s17, s89
    s_lshl_b32 s92, s92, 5
    s_lshr_b32 s93, s15, 1
    s_add_u32 s92, s92, s93
    s_and_b32 s93, s15, 1
    s_lshl2_add_u32 s92, s92, s93
    s_lshl2_add_u32 s92, s92, s16
    s_lshl_b32 s7, s92, 8
    s_add_u32 s19, s7, 16384
    v_mov_b32 v9, s10
    s_waitcnt vmcnt(8)
    s_barrier
    ds_read_b128 a[96:99], v80 offset:0
    ds_read_b128 a[100:103], v81 offset:0
    ds_read_b128 a[104:107], v82 offset:0
    ds_read_b128 a[108:111], v83 offset:0
    s_waitcnt lgkmcnt(3)
    v_mfma_f32_16x16x32_bf16 a[0:3], v[48:51], a[96:99], 0
    buffer_load_dwordx4 v[192:195], v2, s[32:35], s63 offen offset:0
    v_mfma_f32_16x16x32_bf16 a[4:7], v[52:55], a[96:99], 0
    s_waitcnt vmcnt(8)
    ds_read_b128 a[112:115], v84 offset:0
    v_mov_b32_dpp v12, v160 row_ror:8 row_mask:0xf bank_mask:0xf
    v_mfma_f32_16x16x32_bf16 a[8:11], v[56:59], a[96:99], 0
    v_mov_b32_dpp v13, v161 row_ror:8 row_mask:0xf bank_mask:0xf
    v_perm_b32 v64, v12, v160, v4
    v_mfma_f32_16x16x32_bf16 a[12:15], v[60:63], a[96:99], 0
    s_waitcnt lgkmcnt(3)
    ds_read_b128 a[116:119], v85 offset:0
    v_perm_b32 v68, v13, v161, v4
    v_mfma_f32_16x16x32_bf16 a[28:31], v[60:63], a[100:103], 0
    buffer_load_dwordx4 v[196:199], v2, s[32:35], s63 offen offset:2048
    v_mfma_f32_16x16x32_bf16 a[24:27], v[56:59], a[100:103], 0
    ds_read_b128 a[120:123], v86 offset:0
    v_mov_b32_dpp v14, v162 row_ror:8 row_mask:0xf bank_mask:0xf
    v_mfma_f32_16x16x32_bf16 a[20:23], v[52:55], a[100:103], 0
    v_mov_b32_dpp v15, v163 row_ror:8 row_mask:0xf bank_mask:0xf
    v_perm_b32 v72, v14, v162, v4
    v_mfma_f32_16x16x32_bf16 a[16:19], v[48:51], a[100:103], 0
    s_waitcnt vmcnt(8) lgkmcnt(3)
    v_perm_b32 v76, v15, v163, v4
    v_mfma_f32_16x16x32_bf16 a[32:35], a[104:107], v[48:51], 0
    buffer_load_dwordx4 v[200:203], v3, s[32:35], s63 offen offset:0
    v_mfma_f32_16x16x32_bf16 a[36:39], a[104:107], v[52:55], 0
    ds_read_b128 a[124:127], v87 offset:0
    v_mov_b32_dpp v12, v164 row_ror:8 row_mask:0xf bank_mask:0xf
    v_mfma_f32_16x16x32_bf16 a[40:43], a[104:107], v[56:59], 0
    v_mov_b32_dpp v13, v165 row_ror:8 row_mask:0xf bank_mask:0xf
    v_perm_b32 v65, v12, v164, v4
    v_mfma_f32_16x16x32_bf16 a[44:47], a[104:107], v[60:63], 0
    ds_read_b128 a[128:131], v80 offset:16
    v_perm_b32 v69, v13, v165, v4
    v_mfma_f32_16x16x32_bf16 a[60:63], a[108:111], v[60:63], 0
    buffer_load_dwordx4 v[204:207], v3, s[32:35], s63 offen offset:2048
    v_mfma_f32_16x16x32_bf16 a[56:59], a[108:111], v[56:59], 0
    ds_read_b128 a[132:135], v81 offset:16
    v_mov_b32_dpp v14, v166 row_ror:8 row_mask:0xf bank_mask:0xf
    v_mfma_f32_16x16x32_bf16 a[52:55], a[108:111], v[52:55], 0
    v_mov_b32_dpp v15, v167 row_ror:8 row_mask:0xf bank_mask:0xf
    v_perm_b32 v73, v14, v166, v4
    v_mfma_f32_16x16x32_bf16 a[48:51], a[108:111], v[48:51], 0
    s_waitcnt vmcnt(9) lgkmcnt(4)
    v_perm_b32 v77, v15, v167, v4
    v_mfma_f32_16x16x32_bf16 a[64:67], a[112:115], v[48:51], 0
    buffer_load_dwordx4 v[208:211], v2, s[32:35], s64 offen offset:0
    v_mfma_f32_16x16x32_bf16 a[68:71], a[112:115], v[52:55], 0
    ds_read_b128 a[136:139], v82 offset:16
    v_mov_b32_dpp v12, v168 row_ror:8 row_mask:0xf bank_mask:0xf
    v_mfma_f32_16x16x32_bf16 a[72:75], a[112:115], v[56:59], 0
    v_mov_b32_dpp v13, v169 row_ror:8 row_mask:0xf bank_mask:0xf
    v_perm_b32 v66, v12, v168, v4
    v_mfma_f32_16x16x32_bf16 a[76:79], a[112:115], v[60:63], 0
    v_perm_b32 v70, v13, v169, v4
    v_mfma_f32_16x16x32_bf16 a[92:95], a[116:119], v[60:63], 0
    buffer_load_dwordx4 v[212:215], v2, s[32:35], s64 offen offset:2048
    v_mfma_f32_16x16x32_bf16 a[88:91], a[116:119], v[56:59], 0
    ds_read_b128 a[140:143], v83 offset:16
    v_mov_b32_dpp v14, v170 row_ror:8 row_mask:0xf bank_mask:0xf
    v_mfma_f32_16x16x32_bf16 a[84:87], a[116:119], v[52:55], 0
    v_mov_b32_dpp v15, v171 row_ror:8 row_mask:0xf bank_mask:0xf
    v_perm_b32 v74, v14, v170, v4
    v_mfma_f32_16x16x32_bf16 a[80:83], a[116:119], v[48:51], 0
    s_waitcnt vmcnt(10) lgkmcnt(4)
    v_perm_b32 v78, v15, v171, v4
    v_mfma_f32_16x16x32_bf16 v[16:19], a[120:123], v[48:51], 0
    buffer_load_dwordx4 v[216:219], v3, s[32:35], s64 offen offset:0
    v_mfma_f32_16x16x32_bf16 v[20:23], a[120:123], v[52:55], 0
    ds_read_b128 a[144:147], v84 offset:16
    v_mov_b32_dpp v12, v172 row_ror:8 row_mask:0xf bank_mask:0xf
    v_mfma_f32_16x16x32_bf16 v[24:27], a[120:123], v[56:59], 0
    v_mov_b32_dpp v13, v173 row_ror:8 row_mask:0xf bank_mask:0xf
    v_perm_b32 v67, v12, v172, v4
    v_mfma_f32_16x16x32_bf16 v[28:31], a[120:123], v[60:63], 0
    ds_read_b128 a[148:151], v85 offset:16
    v_perm_b32 v71, v13, v173, v4
    v_mfma_f32_16x16x32_bf16 v[44:47], a[124:127], v[60:63], 0
    buffer_load_dwordx4 v[220:223], v3, s[32:35], s64 offen offset:2048
    v_mfma_f32_16x16x32_bf16 v[40:43], a[124:127], v[56:59], 0
    ds_read_b128 a[152:155], v86 offset:16
    v_mov_b32_dpp v14, v174 row_ror:8 row_mask:0xf bank_mask:0xf
    v_mfma_f32_16x16x32_bf16 v[36:39], a[124:127], v[52:55], 0
    v_mov_b32_dpp v15, v175 row_ror:8 row_mask:0xf bank_mask:0xf
    v_perm_b32 v75, v14, v174, v4
    v_mfma_f32_16x16x32_bf16 v[32:35], a[124:127], v[48:51], 0
    s_waitcnt vmcnt(11) lgkmcnt(5)
    v_perm_b32 v79, v15, v175, v4
    v_mfma_f32_16x16x32_bf16 a[0:3], v[64:67], a[128:131], a[0:3]
    buffer_load_dwordx4 v[224:227], v2, s[32:35], s65 offen offset:0
    v_mfma_f32_16x16x32_bf16 a[4:7], v[68:71], a[128:131], a[4:7]
    ds_read_b128 a[156:159], v87 offset:16
    v_mov_b32_dpp v12, v176 row_ror:8 row_mask:0xf bank_mask:0xf
    v_mfma_f32_16x16x32_bf16 a[8:11], v[72:75], a[128:131], a[8:11]
    v_mov_b32_dpp v13, v177 row_ror:8 row_mask:0xf bank_mask:0xf
    v_perm_b32 v48, v12, v176, v4
    v_mfma_f32_16x16x32_bf16 a[12:15], v[76:79], a[128:131], a[12:15]
    v_perm_b32 v52, v13, v177, v4
    v_mfma_f32_16x16x32_bf16 a[28:31], v[76:79], a[132:135], a[28:31]
    buffer_load_dwordx4 v[228:231], v2, s[32:35], s65 offen offset:2048
    v_mfma_f32_16x16x32_bf16 a[24:27], v[72:75], a[132:135], a[24:27]
    ds_read_b128 a[96:99], v80 offset:32
    v_mov_b32_dpp v14, v178 row_ror:8 row_mask:0xf bank_mask:0xf
    v_mfma_f32_16x16x32_bf16 a[20:23], v[68:71], a[132:135], a[20:23]
    v_mov_b32_dpp v15, v179 row_ror:8 row_mask:0xf bank_mask:0xf
    v_perm_b32 v56, v14, v178, v4
    v_mfma_f32_16x16x32_bf16 a[16:19], v[64:67], a[132:135], a[16:19]
    s_waitcnt vmcnt(12) lgkmcnt(5)
    v_perm_b32 v60, v15, v179, v4
    v_mfma_f32_16x16x32_bf16 a[32:35], a[136:139], v[64:67], a[32:35]
L_pg1:
    s_cbranch_execz L_pg2
    buffer_load_dwordx4 v[232:235], v3, s[32:35], s65 offen offset:0
    v_mfma_f32_16x16x32_bf16 a[36:39], a[136:139], v[68:71], a[36:39]
    ds_read_b128 a[100:103], v81 offset:32
    v_mov_b32_dpp v12, v180 row_ror:8 row_mask:0xf bank_mask:0xf
    v_mfma_f32_16x16x32_bf16 a[40:43], a[136:139], v[72:75], a[40:43]
    v_mov_b32_dpp v13, v181 row_ror:8 row_mask:0xf bank_mask:0xf
    v_perm_b32 v49, v12, v180, v4
    v_mfma_f32_16x16x32_bf16 a[44:47], a[136:139], v[76:79], a[44:47]
    ds_read_b128 a[104:107], v82 offset:32
    v_perm_b32 v53, v13, v181, v4
    v_mfma_f32_16x16x32_bf16 a[60:63], a[140:143], v[76:79], a[60:63]
    buffer_load_dwordx4 v[236:239], v3, s[32:35], s65 offen offset:2048
    v_mfma_f32_16x16x32_bf16 a[56:59], a[140:143], v[72:75], a[56:59]
    ds_read_b128 a[108:111], v83 offset:32
    v_mov_b32_dpp v14, v182 row_ror:8 row_mask:0xf bank_mask:0xf
    v_mfma_f32_16x16x32_bf16 a[52:55], a[140:143], v[68:71], a[52:55]
    v_mov_b32_dpp v15, v183 row_ror:8 row_mask:0xf bank_mask:0xf
    v_perm_b32 v57, v14, v182, v4
    v_mfma_f32_16x16x32_bf16 a[48:51], a[140:143], v[64:67], a[48:51]
    s_waitcnt vmcnt(13) lgkmcnt(6)
    v_perm_b32 v61, v15, v183, v4
    v_mfma_f32_16x16x32_bf16 a[64:67], a[144:147], v[64:67], a[64:67]
    buffer_load_dwordx4 v[144:147], v2, s[32:35], s66 offen offset:0
    v_mfma_f32_16x16x32_bf16 a[68:71], a[144:147], v[68:71], a[68:71]
    ds_read_b128 a[112:115], v84 offset:32
    v_mov_b32_dpp v12, v184 row_ror:8 row_mask:0xf bank_mask:0xf
    v_mfma_f32_16x16x32_bf16 a[72:75], a[144:147], v[72:75], a[72:75]
    v_mov_b32_dpp v13, v185 row_ror:8 row_mask:0xf bank_mask:0xf
    v_perm_b32 v50, v12, v184, v4
    v_mfma_f32_16x16x32_bf16 a[76:79], a[144:147], v[76:79], a[76:79]
    v_perm_b32 v54, v13, v185, v4
    v_mfma_f32_16x16x32_bf16 a[92:95], a[148:151], v[76:79], a[92:95]
    buffer_load_dwordx4 v[148:151], v2, s[32:35], s66 offen offset:2048
    v_mfma_f32_16x16x32_bf16 a[88:91], a[148:151], v[72:75], a[88:91]
    ds_read_b128 a[116:119], v85 offset:32
    v_mov_b32_dpp v14, v186 row_ror:8 row_mask:0xf bank_mask:0xf
    v_mfma_f32_16x16x32_bf16 a[84:87], a[148:151], v[68:71], a[84:87]
    v_mov_b32_dpp v15, v187 row_ror:8 row_mask:0xf bank_mask:0xf
    v_perm_b32 v58, v14, v186, v4
    v_mfma_f32_16x16x32_bf16 a[80:83], a[148:151], v[64:67], a[80:83]
    s_waitcnt vmcnt(14) lgkmcnt(6)
    v_perm_b32 v62, v15, v187, v4
    v_mfma_f32_16x16x32_bf16 v[16:19], a[152:155], v[64:67], v[16:19]
    buffer_load_dwordx4 v[152:155], v3, s[32:35], s66 offen offset:0
    v_mfma_f32_16x16x32_bf16 v[20:23], a[152:155], v[68:71], v[20:23]
    ds_read_b128 a[120:123], v86 offset:32
    v_mov_b32_dpp v12, v188 row_ror:8 row_mask:0xf bank_mask:0xf
    v_mfma_f32_16x16x32_bf16 v[24:27], a[152:155], v[72:75], v[24:27]
    v_mov_b32_dpp v13, v189 row_ror:8 row_mask:0xf bank_mask:0xf
    v_perm_b32 v51, v12, v188, v4
    v_mfma_f32_16x16x32_bf16 v[28:31], a[152:155], v[76:79], v[28:31]
    ds_read_b128 a[124:127], v87 offset:32
    v_perm_b32 v55, v13, v189, v4
    v_mfma_f32_16x16x32_bf16 v[44:47], a[156:159], v[76:79], v[44:47]
    buffer_load_dwordx4 v[156:159], v3, s[32:35], s66 offen offset:2048
    v_mfma_f32_16x16x32_bf16 v[40:43], a[156:159], v[72:75], v[40:43]
    ds_read_b128 a[128:131], v80 offset:48
    v_mov_b32_dpp v14, v190 row_ror:8 row_mask:0xf bank_mask:0xf
    v_mfma_f32_16x16x32_bf16 v[36:39], a[156:159], v[68:71], v[36:39]
    v_mov_b32_dpp v15, v191 row_ror:8 row_mask:0xf bank_mask:0xf
    v_perm_b32 v59, v14, v190, v4
    v_mfma_f32_16x16x32_bf16 v[32:35], a[156:159], v[64:67], v[32:35]
    s_waitcnt vmcnt(15) lgkmcnt(7)
    v_perm_b32 v63, v15, v191, v4
    v_mfma_f32_16x16x32_bf16 a[0:3], v[48:51], a[96:99], a[0:3]
    buffer_load_dwordx4 v[160:163], v2, s[32:35], s67 offen offset:0
    v_mfma_f32_16x16x32_bf16 a[4:7], v[52:55], a[96:99], a[4:7]
    ds_read_b128 a[132:135], v81 offset:48
    v_mov_b32_dpp v12, v192 row_ror:8 row_mask:0xf bank_mask:0xf
    v_mfma_f32_16x16x32_bf16 a[8:11], v[56:59], a[96:99], a[8:11]
    v_mov_b32_dpp v13, v193 row_ror:8 row_mask:0xf bank_mask:0xf
    v_perm_b32 v64, v12, v192, v4
    v_mfma_f32_16x16x32_bf16 a[12:15], v[60:63], a[96:99], a[12:15]
    ds_read_b128 a[136:139], v82 offset:48
    v_perm_b32 v68, v13, v193, v4
    v_mfma_f32_16x16x32_bf16 a[28:31], v[60:63], a[100:103], a[28:31]
    buffer_load_dwordx4 v[164:167], v2, s[32:35], s67 offen offset:2048
    v_mfma_f32_16x16x32_bf16 a[24:27], v[56:59], a[100:103], a[24:27]
    ds_read_b128 a[140:143], v83 offset:48
    v_mov_b32_dpp v14, v194 row_ror:8 row_mask:0xf bank_mask:0xf
    v_mfma_f32_16x16x32_bf16 a[20:23], v[52:55], a[100:103], a[20:23]
    v_mov_b32_dpp v15, v195 row_ror:8 row_mask:0xf bank_mask:0xf
    v_perm_b32 v72, v14, v194, v4
    v_mfma_f32_16x16x32_bf16 a[16:19], v[48:51], a[100:103], a[16:19]
    s_waitcnt vmcnt(16) lgkmcnt(8)
    v_perm_b32 v76, v15, v195, v4
    v_mfma_f32_16x16x32_bf16 a[32:35], a[104:107], v[48:51], a[32:35]
    buffer_load_dwordx4 v[168:171], v3, s[32:35], s67 offen offset:0
    v_mfma_f32_16x16x32_bf16 a[36:39], a[104:107], v[52:55], a[36:39]
    ds_read_b128 a[144:147], v84 offset:48
    v_mov_b32_dpp v12, v196 row_ror:8 row_mask:0xf bank_mask:0xf
    v_mfma_f32_16x16x32_bf16 a[40:43], a[104:107], v[56:59], a[40:43]
    v_mov_b32_dpp v13, v197 row_ror:8 row_mask:0xf bank_mask:0xf
    v_perm_b32 v65, v12, v196, v4
    v_mfma_f32_16x16x32_bf16 a[44:47], a[104:107], v[60:63], a[44:47]
    v_perm_b32 v69, v13, v197, v4
    v_mfma_f32_16x16x32_bf16 a[60:63], a[108:111], v[60:63], a[60:63]
    buffer_load_dwordx4 v[172:175], v3, s[32:35], s67 offen offset:2048
    v_mfma_f32_16x16x32_bf16 a[56:59], a[108:111], v[56:59], a[56:59]
    ds_read_b128 a[148:151], v85 offset:48
    v_mov_b32_dpp v14, v198 row_ror:8 row_mask:0xf bank_mask:0xf
    v_mfma_f32_16x16x32_bf16 a[52:55], a[108:111], v[52:55], a[52:55]
    v_mov_b32_dpp v15, v199 row_ror:8 row_mask:0xf bank_mask:0xf
    v_perm_b32 v73, v14, v198, v4
    v_mfma_f32_16x16x32_bf16 a[48:51], a[108:111], v[48:51], a[48:51]
    s_waitcnt vmcnt(17) lgkmcnt(8)
    v_perm_b32 v77, v15, v199, v4
    v_mfma_f32_16x16x32_bf16 a[64:67], a[112:115], v[48:51], a[64:67]
    buffer_load_dwordx4 v[176:179], v2, s[32:35], s68 offen offset:0
    v_mfma_f32_16x16x32_bf16 a[68:71], a[112:115], v[52:55], a[68:71]
    ds_read_b128 a[152:155], v86 offset:48
    v_mov_b32_dpp v12, v200 row_ror:8 row_mask:0xf bank_mask:0xf
    v_mfma_f32_16x16x32_bf16 a[72:75], a[112:115], v[56:59], a[72:75]
    v_mov_b32_dpp v13, v201 row_ror:8 row_mask:0xf bank_mask:0xf
    v_perm_b32 v66, v12, v200, v4
    v_mfma_f32_16x16x32_bf16 a[76:79], a[112:115], v[60:63], a[76:79]
    ds_read_b128 a[156:159], v87 offset:48
    v_perm_b32 v70, v13, v201, v4
    v_mfma_f32_16x16x32_bf16 a[92:95], a[116:119], v[60:63], a[92:95]
    buffer_load_dwordx4 v[180:183], v2, s[32:35], s68 offen offset:2048
    v_mfma_f32_16x16x32_bf16 a[88:91], a[116:119], v[56:59], a[88:91]
    ds_read_b128 a[96:99], v88 offset:0
    v_mov_b32_dpp v14, v202 row_ror:8 row_mask:0xf bank_mask:0xf
    v_mfma_f32_16x16x32_bf16 a[84:87], a[116:119], v[52:55], a[84:87]
    v_mov_b32_dpp v15, v203 row_ror:8 row_mask:0xf bank_mask:0xf
    v_perm_b32 v74, v14, v202, v4
    v_mfma_f32_16x16x32_bf16 a[80:83], a[116:119], v[48:51], a[80:83]
    s_waitcnt vmcnt(18) lgkmcnt(9)
    v_perm_b32 v78, v15, v203, v4
    v_mfma_f32_16x16x32_bf16 v[16:19], a[120:123], v[48:51], v[16:19]
    buffer_load_dwordx4 v[184:187], v3, s[32:35], s68 offen offset:0
    v_mfma_f32_16x16x32_bf16 v[20:23], a[120:123], v[52:55], v[20:23]
    ds_read_b128 a[100:103], v89 offset:0
    v_mov_b32_dpp v12, v204 row_ror:8 row_mask:0xf bank_mask:0xf
    v_mfma_f32_16x16x32_bf16 v[24:27], a[120:123], v[56:59], v[24:27]
    v_mov_b32_dpp v13, v205 row_ror:8 row_mask:0xf bank_mask:0xf
    v_perm_b32 v67, v12, v204, v4
    v_mfma_f32_16x16x32_bf16 v[28:31], a[120:123], v[60:63], v[28:31]
    v_perm_b32 v71, v13, v205, v4
    v_mfma_f32_16x16x32_bf16 v[44:47], a[124:127], v[60:63], v[44:47]
    buffer_load_dwordx4 v[188:191], v3, s[32:35], s68 offen offset:2048
    v_mfma_f32_16x16x32_bf16 v[40:43], a[124:127], v[56:59], v[40:43]
    ds_read_b128 a[104:107], v90 offset:0
    v_mov_b32_dpp v14, v206 row_ror:8 row_mask:0xf bank_mask:0xf
    v_mfma_f32_16x16x32_bf16 v[36:39], a[124:127], v[52:55], v[36:39]
    v_mov_b32_dpp v15, v207 row_ror:8 row_mask:0xf bank_mask:0xf
    v_perm_b32 v75, v14, v206, v4
    v_mfma_f32_16x16x32_bf16 v[32:35], a[124:127], v[48:51], v[32:35]
    s_waitcnt vmcnt(19) lgkmcnt(9)
    v_perm_b32 v79, v15, v207, v4
    v_mfma_f32_16x16x32_bf16 a[0:3], v[64:67], a[128:131], a[0:3]
    v_mfma_f32_16x16x32_bf16 a[4:7], v[68:71], a[128:131], a[4:7]
    s_mov_b32 m0, 153600
    ds_read_b128 a[108:111], v91 offset:0
    v_mov_b32_dpp v12, v208 row_ror:8 row_mask:0xf bank_mask:0xf
    v_mfma_f32_16x16x32_bf16 a[8:11], v[72:75], a[128:131], a[8:11]
    v_mov_b32_dpp v13, v209 row_ror:8 row_mask:0xf bank_mask:0xf
    v_perm_b32 v48, v12, v208, v4
    v_mfma_f32_16x16x32_bf16 a[12:15], v[76:79], a[128:131], a[12:15]
    ds_read_b128 a[112:115], v92 offset:0
    v_perm_b32 v52, v13, v209, v4
    v_mfma_f32_16x16x32_bf16 a[28:31], v[76:79], a[132:135], a[28:31]
    v_mov_b32 v6, v140
    v_mfma_f32_16x16x32_bf16 a[24:27], v[72:75], a[132:135], a[24:27]
    s_movk_i32 s97, 0x4000
    ds_read_b128 a[116:119], v93 offset:0
    v_mov_b32_dpp v14, v210 row_ror:8 row_mask:0xf bank_mask:0xf
    v_mfma_f32_16x16x32_bf16 a[20:23], v[68:71], a[132:135], a[20:23]
    v_mov_b32_dpp v15, v211 row_ror:8 row_mask:0xf bank_mask:0xf
    v_perm_b32 v56, v14, v210, v4
    v_mfma_f32_16x16x32_bf16 a[16:19], v[64:67], a[132:135], a[16:19]
    s_waitcnt vmcnt(18) lgkmcnt(10)
    v_perm_b32 v60, v15, v211, v4
    v_mfma_f32_16x16x32_bf16 a[32:35], a[136:139], v[64:67], a[32:35]
    v_mfma_f32_16x16x32_bf16 a[36:39], a[136:139], v[68:71], a[36:39]
    ds_read_b128 a[120:123], v94 offset:0
    v_mov_b32_dpp v12, v212 row_ror:8 row_mask:0xf bank_mask:0xf
    v_mfma_f32_16x16x32_bf16 a[40:43], a[136:139], v[72:75], a[40:43]
    v_mov_b32_dpp v13, v213 row_ror:8 row_mask:0xf bank_mask:0xf
    v_perm_b32 v49, v12, v212, v4
    v_mfma_f32_16x16x32_bf16 a[44:47], a[136:139], v[76:79], a[44:47]
    ds_read_b128 a[124:127], v95 offset:0
    v_perm_b32 v53, v13, v213, v4
    v_mfma_f32_16x16x32_bf16 a[60:63], a[140:143], v[76:79], a[60:63]
    v_mfma_f32_16x16x32_bf16 a[56:59], a[140:143], v[72:75], a[56:59]
    ds_read_b128 a[128:131], v91 offset:16
    v_mov_b32_dpp v14, v214 row_ror:8 row_mask:0xf bank_mask:0xf
    v_mfma_f32_16x16x32_bf16 a[52:55], a[140:143], v[68:71], a[52:55]
    v_mov_b32_dpp v15, v215 row_ror:8 row_mask:0xf bank_mask:0xf
    v_perm_b32 v57, v14, v214, v4
    v_mfma_f32_16x16x32_bf16 a[48:51], a[140:143], v[64:67], a[48:51]
    s_waitcnt vmcnt(17) lgkmcnt(11)
    v_perm_b32 v61, v15, v215, v4
    v_mfma_f32_16x16x32_bf16 a[64:67], a[144:147], v[64:67], a[64:67]
    global_load_lds_dwordx4 v5, s[52:53]
    v_mfma_f32_16x16x32_bf16 a[68:71], a[144:147], v[68:71], a[68:71]
    s_mov_b32 m0, 154624
    ds_read_b128 a[132:135], v92 offset:16
    v_mov_b32_dpp v12, v216 row_ror:8 row_mask:0xf bank_mask:0xf
    v_mfma_f32_16x16x32_bf16 a[72:75], a[144:147], v[72:75], a[72:75]
    v_mov_b32_dpp v13, v217 row_ror:8 row_mask:0xf bank_mask:0xf
    v_perm_b32 v50, v12, v216, v4
    v_mfma_f32_16x16x32_bf16 a[76:79], a[144:147], v[76:79], a[76:79]
    ds_read_b128 a[136:139], v93 offset:16
    v_perm_b32 v54, v13, v217, v4
    v_mfma_f32_16x16x32_bf16 a[92:95], a[148:151], v[76:79], a[92:95]
    global_load_lds_dwordx4 v5, s[54:55]
    v_mfma_f32_16x16x32_bf16 a[88:91], a[148:151], v[72:75], a[88:91]
    s_mov_b32 m0, s5
    ds_read_b128 a[140:143], v95 offset:16
    v_mov_b32_dpp v14, v218 row_ror:8 row_mask:0xf bank_mask:0xf
    v_mfma_f32_16x16x32_bf16 a[84:87], a[148:151], v[68:71], a[84:87]
    v_mov_b32_dpp v15, v219 row_ror:8 row_mask:0xf bank_mask:0xf
    v_perm_b32 v58, v14, v218, v4
    v_mfma_f32_16x16x32_bf16 a[80:83], a[148:151], v[64:67], a[80:83]
    s_waitcnt vmcnt(18) lgkmcnt(12)
    v_perm_b32 v62, v15, v219, v4
    v_mfma_f32_16x16x32_bf16 v[16:19], a[152:155], v[64:67], v[16:19]
    global_load_short_d16_hi v244, v244, s[56:57]
    v_mfma_f32_16x16x32_bf16 v[20:23], a[152:155], v[68:71], v[20:23]
    ds_read_b128 a[144:147], v88 offset:16
    v_mov_b32_dpp v12, v220 row_ror:8 row_mask:0xf bank_mask:0xf
    v_mfma_f32_16x16x32_bf16 v[24:27], a[152:155], v[72:75], v[24:27]
    v_mov_b32_dpp v13, v221 row_ror:8 row_mask:0xf bank_mask:0xf
    v_perm_b32 v51, v12, v220, v4
    v_mfma_f32_16x16x32_bf16 v[28:31], a[152:155], v[76:79], v[28:31]
    v_perm_b32 v55, v13, v221, v4
    v_mfma_f32_16x16x32_bf16 v[44:47], a[156:159], v[76:79], v[44:47]
    buffer_load_dwordx4 v5, s[40:43], s4 offen offset:0 lds
    v_mfma_f32_16x16x32_bf16 v[40:43], a[156:159], v[72:75], v[40:43]
    ds_read_b128 a[148:151], v88 offset:32
    v_mov_b32_dpp v14, v222 row_ror:8 row_mask:0xf bank_mask:0xf
    v_mfma_f32_16x16x32_bf16 v[36:39], a[156:159], v[68:71], v[36:39]
    v_mov_b32_dpp v15, v223 row_ror:8 row_mask:0xf bank_mask:0xf
    v_perm_b32 v59, v14, v222, v4
    v_mfma_f32_16x16x32_bf16 v[32:35], a[156:159], v[64:67], v[32:35]
    s_waitcnt vmcnt(18) lgkmcnt(12)
    v_perm_b32 v63, v15, v223, v4
    v_mfma_f32_16x16x32_bf16 a[0:3], v[48:51], a[96:99], a[0:3]
    buffer_load_dwordx4 v5, s[40:43], s4 offen offset:1024 lds
    v_mfma_f32_16x16x32_bf16 a[4:7], v[52:55], a[96:99], a[4:7]
    ds_read_b128 a[152:155], v89 offset:16
    v_mov_b32_dpp v12, v224 row_ror:8 row_mask:0xf bank_mask:0xf
    v_mfma_f32_16x16x32_bf16 a[8:11], v[56:59], a[96:99], a[8:11]
    v_mov_b32_dpp v13, v225 row_ror:8 row_mask:0xf bank_mask:0xf
    v_perm_b32 v64, v12, v224, v4
    v_mfma_f32_16x16x32_bf16 a[12:15], v[60:63], a[96:99], a[12:15]
    v_perm_b32 v68, v13, v225, v4
    v_mov_b32_dpp v14, v226 row_ror:8 row_mask:0xf bank_mask:0xf
    v_mfma_f32_16x16x32_bf16 a[28:31], v[60:63], a[100:103], a[28:31]
    buffer_load_dwordx4 v5, s[40:43], s4 offen offset:2048 lds
    v_mfma_f32_16x16x32_bf16 a[24:27], v[56:59], a[100:103], a[24:27]
    s_add_u32 m0, s5, 3072
    ds_read_b128 a[156:159], v89 offset:32
    v_mov_b32_dpp v15, v227 row_ror:8 row_mask:0xf bank_mask:0xf
    v_mfma_f32_16x16x32_bf16 a[20:23], v[52:55], a[100:103], a[20:23]
    ds_read_b128 v[240:243], v141 offset:0
    v_perm_b32 v72, v14, v226, v4
    v_mfma_f32_16x16x32_bf16 a[16:19], v[48:51], a[100:103], a[16:19]
    s_waitcnt vmcnt(19) lgkmcnt(13)
    v_perm_b32 v76, v15, v227, v4
    v_mov_b32_dpp v12, v228 row_ror:8 row_mask:0xf bank_mask:0xf
    v_mfma_f32_16x16x32_bf16 a[32:35], a[104:107], v[48:51], a[32:35]
    buffer_load_dwordx4 v5, s[40:43], s51 offen offset:0 lds
    v_mfma_f32_16x16x32_bf16 a[36:39], a[104:107], v[52:55], a[36:39]
    ds_read_b128 a[96:99], v90 offset:16
    v_mov_b32_dpp v13, v229 row_ror:8 row_mask:0xf bank_mask:0xf
    v_mfma_f32_16x16x32_bf16 a[40:43], a[104:107], v[56:59], a[40:43]
    v_perm_b32 v65, v12, v228, v4
    v_perm_b32 v69, v13, v229, v4
    v_mfma_f32_16x16x32_bf16 a[44:47], a[104:107], v[60:63], a[44:47]
    v_mov_b32_dpp v14, v230 row_ror:8 row_mask:0xf bank_mask:0xf
    v_mov_b32_dpp v15, v231 row_ror:8 row_mask:0xf bank_mask:0xf
    v_mfma_f32_16x16x32_bf16 a[60:63], a[108:111], v[60:63], a[60:63]
    buffer_load_dwordx4 v5, s[40:43], s51 offen offset:1024 lds
    v_mfma_f32_16x16x32_bf16 a[56:59], a[108:111], v[56:59], a[56:59]
    ds_read_b128 a[100:103], v90 offset:32
    v_perm_b32 v73, v14, v230, v4
    v_mfma_f32_16x16x32_bf16 a[52:55], a[108:111], v[52:55], a[52:55]
    v_perm_b32 v77, v15, v231, v4
    v_mov_b32_dpp v12, v232 row_ror:8 row_mask:0xf bank_mask:0xf
    v_mfma_f32_16x16x32_bf16 a[48:51], a[108:111], v[48:51], a[48:51]
    s_waitcnt vmcnt(20) lgkmcnt(2)
    v_mov_b32_dpp v13, v233 row_ror:8 row_mask:0xf bank_mask:0xf
    v_perm_b32 v66, v12, v232, v4
    v_mfma_f32_16x16x32_bf16 a[64:67], a[112:115], v[48:51], a[64:67]
    v_lshl_add_u32 v240, v240, 8, v11
    v_lshl_add_u32 v241, v241, 8, v11
    v_mfma_f32_16x16x32_bf16 a[68:71], a[112:115], v[52:55], a[68:71]
    ds_read_b128 a[104:107], v94 offset:16
    v_lshl_add_u32 v242, v242, 8, v11
    v_mfma_f32_16x16x32_bf16 a[72:75], a[112:115], v[56:59], a[72:75]
    v_lshl_add_u32 v243, v243, 8, v11
    v_perm_b32 v70, v13, v233, v4
    v_mfma_f32_16x16x32_bf16 a[76:79], a[112:115], v[60:63], a[76:79]
    v_mov_b32_dpp v14, v234 row_ror:8 row_mask:0xf bank_mask:0xf
    v_mov_b32_dpp v15, v235 row_ror:8 row_mask:0xf bank_mask:0xf
    v_mfma_f32_16x16x32_bf16 a[92:95], a[116:119], v[60:63], a[92:95]
    ds_read_b128 v[136:139], v141 offset:64
    v_perm_b32 v74, v14, v234, v4
    v_mfma_f32_16x16x32_bf16 a[88:91], a[116:119], v[56:59], a[88:91]
    ds_read_b128 a[108:111], v94 offset:32
    v_perm_b32 v78, v15, v235, v4
    v_mfma_f32_16x16x32_bf16 a[84:87], a[116:119], v[52:55], a[84:87]
    v_mov_b32_dpp v12, v236 row_ror:8 row_mask:0xf bank_mask:0xf
    v_mov_b32_dpp v13, v237 row_ror:8 row_mask:0xf bank_mask:0xf
    v_mfma_f32_16x16x32_bf16 a[80:83], a[116:119], v[48:51], a[80:83]
    s_waitcnt vmcnt(18)
    v_perm_b32 v67, v12, v236, v4
    v_perm_b32 v71, v13, v237, v4
    v_mfma_f32_16x16x32_bf16 v[16:19], a[120:123], v[48:51], v[16:19]
    v_mov_b32_dpp v14, v238 row_ror:8 row_mask:0xf bank_mask:0xf
    v_mov_b32_dpp v15, v239 row_ror:8 row_mask:0xf bank_mask:0xf
    v_mfma_f32_16x16x32_bf16 v[20:23], a[120:123], v[52:55], v[20:23]
    ds_read_b128 a[112:115], v91 offset:32
    v_perm_b32 v75, v14, v238, v4
    v_mfma_f32_16x16x32_bf16 v[24:27], a[120:123], v[56:59], v[24:27]
    v_perm_b32 v79, v15, v239, v4
    v_mov_b32_dpp v12, v144 row_ror:8 row_mask:0xf bank_mask:0xf
    v_mfma_f32_16x16x32_bf16 v[28:31], a[120:123], v[60:63], v[28:31]
    v_mov_b32_dpp v13, v145 row_ror:8 row_mask:0xf bank_mask:0xf
    v_perm_b32 v224, v12, v144, v4
    v_mfma_f32_16x16x32_bf16 v[44:47], a[124:127], v[60:63], v[44:47]
    v_perm_b32 v228, v13, v145, v4
    v_mov_b32_dpp v14, v146 row_ror:8 row_mask:0xf bank_mask:0xf
    v_mfma_f32_16x16x32_bf16 v[40:43], a[124:127], v[56:59], v[40:43]
    ds_read_b128 a[116:119], v91 offset:48
    v_mov_b32_dpp v15, v147 row_ror:8 row_mask:0xf bank_mask:0xf
    v_mfma_f32_16x16x32_bf16 v[36:39], a[124:127], v[52:55], v[36:39]
    v_perm_b32 v232, v14, v146, v4
    v_perm_b32 v236, v15, v147, v4
    v_mov_b32_dpp v12, v148 row_ror:8 row_mask:0xf bank_mask:0xf
    v_mfma_f32_16x16x32_bf16 v[32:35], a[124:127], v[48:51], v[32:35]
    s_waitcnt vmcnt(17) lgkmcnt(3)
    v_mov_b32_dpp v13, v149 row_ror:8 row_mask:0xf bank_mask:0xf
    v_perm_b32 v225, v12, v148, v4
    v_mfma_f32_16x16x32_bf16 a[48:51], a[128:131], v[64:67], a[48:51]
    v_lshl_add_u32 v136, v136, 8, v11
    v_lshl_add_u32 v137, v137, 8, v11
    v_mfma_f32_16x16x32_bf16 a[52:55], a[128:131], v[68:71], a[52:55]
    ds_read_b128 a[120:123], v92 offset:32
    v_lshl_add_u32 v138, v138, 8, v11
    v_mfma_f32_16x16x32_bf16 a[56:59], a[128:131], v[72:75], a[56:59]
    v_lshl_add_u32 v139, v139, 8, v11
    v_perm_b32 v229, v13, v149, v4
    v_mfma_f32_16x16x32_bf16 a[60:63], a[128:131], v[76:79], a[60:63]
    v_mov_b32_dpp v14, v150 row_ror:8 row_mask:0xf bank_mask:0xf
    v_mov_b32_dpp v15, v151 row_ror:8 row_mask:0xf bank_mask:0xf
    v_mfma_f32_16x16x32_bf16 a[76:79], a[132:135], v[76:79], a[76:79]
    buffer_load_dwordx4 v[192:195], v2, s[32:35], s69 offen offset:0
    v_mfma_f32_16x16x32_bf16 a[72:75], a[132:135], v[72:75], a[72:75]
    s_add_u32 m0, s3, 0
    ds_read_b128 a[124:127], v92 offset:48
    v_perm_b32 v233, v14, v150, v4
    v_mfma_f32_16x16x32_bf16 a[68:71], a[132:135], v[68:71], a[68:71]
    v_perm_b32 v237, v15, v151, v4
    v_mov_b32_dpp v12, v152 row_ror:8 row_mask:0xf bank_mask:0xf
    v_mov_b32_dpp v13, v153 row_ror:8 row_mask:0xf bank_mask:0xf
    v_mfma_f32_16x16x32_bf16 a[64:67], a[132:135], v[64:67], a[64:67]
    s_waitcnt vmcnt(17)
    v_perm_b32 v226, v12, v152, v4
    v_perm_b32 v230, v13, v153, v4
    v_mfma_f32_16x16x32_bf16 a[80:83], a[136:139], v[64:67], a[80:83]
    buffer_load_dwordx4 v[196:199], v2, s[32:35], s69 offen offset:2048
    v_mfma_f32_16x16x32_bf16 a[84:87], a[136:139], v[68:71], a[84:87]
    ds_read_b128 a[128:131], v93 offset:32
    v_mov_b32_dpp v14, v154 row_ror:8 row_mask:0xf bank_mask:0xf
    v_mfma_f32_16x16x32_bf16 a[88:91], a[136:139], v[72:75], a[88:91]
    v_mov_b32_dpp v15, v155 row_ror:8 row_mask:0xf bank_mask:0xf
    v_perm_b32 v234, v14, v154, v4
    v_perm_b32 v238, v15, v155, v4
    v_mfma_f32_16x16x32_bf16 a[92:95], a[136:139], v[76:79], a[92:95]
    v_mov_b32_dpp v12, v156 row_ror:8 row_mask:0xf bank_mask:0xf
    v_mov_b32_dpp v13, v157 row_ror:8 row_mask:0xf bank_mask:0xf
    v_mfma_f32_16x16x32_bf16 v[44:47], a[140:143], v[76:79], v[44:47]
    buffer_load_dwordx4 v[200:203], v3, s[32:35], s69 offen offset:0
    v_mfma_f32_16x16x32_bf16 v[40:43], a[140:143], v[72:75], v[40:43]
    ds_read_b128 a[132:135], v93 offset:48
    v_perm_b32 v227, v12, v156, v4
    v_mfma_f32_16x16x32_bf16 v[36:39], a[140:143], v[68:71], v[36:39]
    v_perm_b32 v231, v13, v157, v4
    v_mov_b32_dpp v14, v158 row_ror:8 row_mask:0xf bank_mask:0xf
    v_mov_b32_dpp v15, v159 row_ror:8 row_mask:0xf bank_mask:0xf
    v_mfma_f32_16x16x32_bf16 v[32:35], a[140:143], v[64:67], v[32:35]
    s_waitcnt vmcnt(17)
    v_perm_b32 v235, v14, v158, v4
    v_perm_b32 v239, v15, v159, v4
    v_mfma_f32_16x16x32_bf16 a[0:3], v[64:67], a[144:147], a[0:3]
    buffer_load_dwordx4 v[204:207], v3, s[32:35], s69 offen offset:2048
    v_mfma_f32_16x16x32_bf16 a[0:3], v[224:227], a[148:151], a[0:3]
    ds_read_b128 a[136:139], v95 offset:32
    v_mov_b32_dpp v12, v160 row_ror:8 row_mask:0xf bank_mask:0xf
    v_mfma_f32_16x16x32_bf16 a[4:7], v[228:231], a[148:151], a[4:7]
    v_mov_b32_dpp v13, v161 row_ror:8 row_mask:0xf bank_mask:0xf
    v_perm_b32 v144, v12, v160, v4
    v_mfma_f32_16x16x32_bf16 a[4:7], v[68:71], a[144:147], a[4:7]
    v_perm_b32 v148, v13, v161, v4
    v_mov_b32_dpp v14, v162 row_ror:8 row_mask:0xf bank_mask:0xf
    v_mfma_f32_16x16x32_bf16 a[8:11], v[72:75], a[144:147], a[8:11]
    buffer_load_dwordx4 v240, s[28:31], s44 offen offset:0 lds
    v_mfma_f32_16x16x32_bf16 a[8:11], v[232:235], a[148:151], a[8:11]
    ds_read_b128 a[140:143], v95 offset:48
    v_mov_b32_dpp v15, v163 row_ror:8 row_mask:0xf bank_mask:0xf
    v_mfma_f32_16x16x32_bf16 a[12:15], v[236:239], a[148:151], a[12:15]
    v_perm_b32 v152, v14, v162, v4
    v_perm_b32 v156, v15, v163, v4
    v_mfma_f32_16x16x32_bf16 a[12:15], v[76:79], a[144:147], a[12:15]
    s_waitcnt vmcnt(18)
    v_mov_b32_dpp v12, v164 row_ror:8 row_mask:0xf bank_mask:0xf
    v_mov_b32_dpp v13, v165 row_ror:8 row_mask:0xf bank_mask:0xf
    v_mfma_f32_16x16x32_bf16 a[28:31], v[76:79], a[152:155], a[28:31]
    buffer_load_dwordx4 v241, s[28:31], s45 offen offset:1088 lds
    v_mfma_f32_16x16x32_bf16 a[28:31], v[236:239], a[156:159], a[28:31]
    ds_read_b128 a[144:147], v88 offset:48
    v_perm_b32 v145, v12, v164, v4
    v_mfma_f32_16x16x32_bf16 a[24:27], v[232:235], a[156:159], a[24:27]
    v_perm_b32 v149, v13, v165, v4
    v_mov_b32_dpp v14, v166 row_ror:8 row_mask:0xf bank_mask:0xf
    v_mfma_f32_16x16x32_bf16 a[24:27], v[72:75], a[152:155], a[24:27]
    v_mov_b32_dpp v15, v167 row_ror:8 row_mask:0xf bank_mask:0xf
    v_perm_b32 v153, v14, v166, v4
    v_mfma_f32_16x16x32_bf16 a[20:23], v[68:71], a[152:155], a[20:23]
    buffer_load_dwordx4 v242, s[28:31], s46 offen offset:2176 lds
    v_mfma_f32_16x16x32_bf16 a[20:23], v[228:231], a[156:159], a[20:23]
    ds_read_b128 a[148:151], v96 offset:0
    v_perm_b32 v157, v15, v167, v4
    v_mfma_f32_16x16x32_bf16 a[16:19], v[224:227], a[156:159], a[16:19]
    v_mov_b32_dpp v12, v168 row_ror:8 row_mask:0xf bank_mask:0xf
    v_mov_b32_dpp v13, v169 row_ror:8 row_mask:0xf bank_mask:0xf
    v_mfma_f32_16x16x32_bf16 a[16:19], v[64:67], a[152:155], a[16:19]
    s_waitcnt vmcnt(19)
    v_perm_b32 v146, v12, v168, v4
    v_perm_b32 v150, v13, v169, v4
    v_mfma_f32_16x16x32_bf16 a[32:35], a[96:99], v[64:67], a[32:35]
    buffer_load_dwordx4 v243, s[28:31], 0 offen offset:3264 lds
    v_mfma_f32_16x16x32_bf16 a[32:35], a[100:103], v[224:227], a[32:35]
    s_add_u32 m0, s3, 17408
    ds_read_b128 a[152:155], v89 offset:48
    v_mov_b32_dpp v14, v170 row_ror:8 row_mask:0xf bank_mask:0xf
    v_mfma_f32_16x16x32_bf16 a[36:39], a[100:103], v[228:231], a[36:39]
    ds_read_b128 v[240:243], v141 offset:128
    v_mov_b32_dpp v15, v171 row_ror:8 row_mask:0xf bank_mask:0xf
    v_mfma_f32_16x16x32_bf16 a[36:39], a[96:99], v[68:71], a[36:39]
    v_perm_b32 v154, v14, v170, v4
    v_perm_b32 v158, v15, v171, v4
    v_mfma_f32_16x16x32_bf16 a[40:43], a[96:99], v[72:75], a[40:43]
    buffer_load_dwordx4 v136, s[28:31], s44 offen offset:0 lds
    v_mfma_f32_16x16x32_bf16 a[40:43], a[100:103], v[232:235], a[40:43]
    ds_read_b128 a[156:159], v97 offset:0
    v_mov_b32_dpp v12, v172 row_ror:8 row_mask:0xf bank_mask:0xf
    v_mfma_f32_16x16x32_bf16 a[44:47], a[100:103], v[236:239], a[44:47]
    v_mov_b32_dpp v13, v173 row_ror:8 row_mask:0xf bank_mask:0xf
    v_perm_b32 v147, v12, v172, v4
    v_mfma_f32_16x16x32_bf16 a[44:47], a[96:99], v[76:79], a[44:47]
    s_waitcnt vmcnt(20) lgkmcnt(13)
    v_perm_b32 v151, v13, v173, v4
    v_mov_b32_dpp v14, v174 row_ror:8 row_mask:0xf bank_mask:0xf
    v_mfma_f32_16x16x32_bf16 v[28:31], a[104:107], v[76:79], v[28:31]
    buffer_load_dwordx4 v137, s[28:31], s45 offen offset:1088 lds
    v_mfma_f32_16x16x32_bf16 v[28:31], a[108:111], v[236:239], v[28:31]
    ds_read_b128 a[96:99], v90 offset:48
    v_mov_b32_dpp v15, v175 row_ror:8 row_mask:0xf bank_mask:0xf
    v_mfma_f32_16x16x32_bf16 v[24:27], a[108:111], v[232:235], v[24:27]
    v_perm_b32 v155, v14, v174, v4
    v_perm_b32 v159, v15, v175, v4
    v_mfma_f32_16x16x32_bf16 v[24:27], a[104:107], v[72:75], v[24:27]
    v_mov_b32_dpp v12, v176 row_ror:8 row_mask:0xf bank_mask:0xf
    v_mov_b32_dpp v13, v177 row_ror:8 row_mask:0xf bank_mask:0xf
    v_mfma_f32_16x16x32_bf16 v[20:23], a[104:107], v[68:71], v[20:23]
    buffer_load_dwordx4 v138, s[28:31], s46 offen offset:2176 lds
    v_mfma_f32_16x16x32_bf16 v[20:23], a[108:111], v[228:231], v[20:23]
    ds_read_b128 a[100:103], v98 offset:0
    v_perm_b32 v160, v12, v176, v4
    v_mfma_f32_16x16x32_bf16 v[16:19], a[108:111], v[224:227], v[16:19]
    v_perm_b32 v164, v13, v177, v4
    v_mov_b32_dpp v14, v178 row_ror:8 row_mask:0xf bank_mask:0xf
    v_mfma_f32_16x16x32_bf16 v[16:19], a[104:107], v[64:67], v[16:19]
    s_waitcnt vmcnt(21) lgkmcnt(3)
    v_mov_b32_dpp v15, v179 row_ror:8 row_mask:0xf bank_mask:0xf
    v_perm_b32 v168, v14, v178, v4
    v_mfma_f32_16x16x32_bf16 a[48:51], a[112:115], v[224:227], a[48:51]
    buffer_load_dwordx4 v139, s[28:31], 0 offen offset:3264 lds
    v_mfma_f32_16x16x32_bf16 a[48:51], a[116:119], v[144:147], a[48:51]
    ds_read_b128 a[104:107], v94 offset:48
    v_lshl_add_u32 v240, v240, 8, v11
    v_mfma_f32_16x16x32_bf16 a[52:55], a[116:119], v[148:151], a[52:55]
    v_lshl_add_u32 v241, v241, 8, v11
    v_lshl_add_u32 v242, v242, 8, v11
    v_mfma_f32_16x16x32_bf16 a[52:55], a[112:115], v[228:231], a[52:55]
    v_lshl_add_u32 v243, v243, 8, v11
    v_mov_b32 v92, s12
    v_mfma_f32_16x16x32_bf16 a[56:59], a[112:115], v[232:235], a[56:59]
    buffer_load_dwordx4 v[208:211], v2, s[32:35], s70 offen offset:0
    v_mfma_f32_16x16x32_bf16 a[56:59], a[116:119], v[152:155], a[56:59]
    s_add_u32 m0, s3, 34816
    ds_read_b128 a[108:111], v102 offset:0
    v_mov_b32 v93, s12
    v_mfma_f32_16x16x32_bf16 a[60:63], a[116:119], v[156:159], a[60:63]
    v_mov_b32 v94, s12
    v_mov_b32 v95, s12
    v_mfma_f32_16x16x32_bf16 a[60:63], a[112:115], v[236:239], a[60:63]
    s_waitcnt vmcnt(22)
    v_perm_b32 v172, v15, v179, v4
    v_mov_b32_dpp v12, v180 row_ror:8 row_mask:0xf bank_mask:0xf
    v_mfma_f32_16x16x32_bf16 a[76:79], a[120:123], v[236:239], a[76:79]
    buffer_load_dwordx4 v[212:215], v2, s[32:35], s70 offen offset:2048
    v_mfma_f32_16x16x32_bf16 a[76:79], a[124:127], v[156:159], a[76:79]
    ds_read_b128 a[112:115], v99 offset:0
    v_mov_b32_dpp v13, v181 row_ror:8 row_mask:0xf bank_mask:0xf
    v_mfma_f32_16x16x32_bf16 a[72:75], a[124:127], v[152:155], a[72:75]
    v_perm_b32 v161, v12, v180, v4
    v_perm_b32 v165, v13, v181, v4
    v_mfma_f32_16x16x32_bf16 a[72:75], a[120:123], v[232:235], a[72:75]
    v_mov_b32_dpp v14, v182 row_ror:8 row_mask:0xf bank_mask:0xf
    v_mov_b32_dpp v15, v183 row_ror:8 row_mask:0xf bank_mask:0xf
    v_mfma_f32_16x16x32_bf16 a[68:71], a[120:123], v[228:231], a[68:71]
    buffer_load_dwordx4 v[216:219], v3, s[32:35], s70 offen offset:0
    v_mfma_f32_16x16x32_bf16 a[68:71], a[124:127], v[148:151], a[68:71]
    ds_read_b128 a[116:119], v99 offset:16
    v_perm_b32 v169, v14, v182, v4
    v_mfma_f32_16x16x32_bf16 a[64:67], a[124:127], v[144:147], a[64:67]
    v_perm_b32 v173, v15, v183, v4
    v_mov_b32_dpp v12, v184 row_ror:8 row_mask:0xf bank_mask:0xf
    v_mfma_f32_16x16x32_bf16 a[64:67], a[120:123], v[224:227], a[64:67]
    s_waitcnt vmcnt(23)
    v_mov_b32_dpp v13, v185 row_ror:8 row_mask:0xf bank_mask:0xf
    v_perm_b32 v162, v12, v184, v4
    v_mfma_f32_16x16x32_bf16 a[80:83], a[128:131], v[224:227], a[80:83]
L_pg2:
    s_cbranch_execz L_pg3
    buffer_load_dwordx4 v[220:223], v3, s[32:35], s70 offen offset:2048
    v_mfma_f32_16x16x32_bf16 a[80:83], a[132:135], v[144:147], a[80:83]
    ds_read_b128 a[120:123], v100 offset:0
    v_perm_b32 v166, v13, v185, v4
    v_mfma_f32_16x16x32_bf16 a[84:87], a[132:135], v[148:151], a[84:87]
    v_mov_b32_dpp v14, v186 row_ror:8 row_mask:0xf bank_mask:0xf
    v_mov_b32_dpp v15, v187 row_ror:8 row_mask:0xf bank_mask:0xf
    v_mfma_f32_16x16x32_bf16 a[84:87], a[128:131], v[228:231], a[84:87]
    v_perm_b32 v170, v14, v186, v4
    v_perm_b32 v174, v15, v187, v4
    v_mfma_f32_16x16x32_bf16 a[88:91], a[128:131], v[232:235], a[88:91]
    buffer_load_dwordx4 v240, s[28:31], s44 offen offset:0 lds
    v_mfma_f32_16x16x32_bf16 a[88:91], a[132:135], v[152:155], a[88:91]
    ds_read_b128 a[124:127], v100 offset:16
    v_mov_b32_dpp v12, v188 row_ror:8 row_mask:0xf bank_mask:0xf
    v_mfma_f32_16x16x32_bf16 a[92:95], a[132:135], v[156:159], a[92:95]
    v_mov_b32_dpp v13, v189 row_ror:8 row_mask:0xf bank_mask:0xf
    v_perm_b32 v163, v12, v188, v4
    v_mfma_f32_16x16x32_bf16 a[92:95], a[128:131], v[236:239], a[92:95]
    s_waitcnt vmcnt(16)
    v_perm_b32 v167, v13, v189, v4
    v_mov_b32_dpp v14, v190 row_ror:8 row_mask:0xf bank_mask:0xf
    v_mfma_f32_16x16x32_bf16 v[44:47], a[136:139], v[236:239], v[44:47]
    buffer_load_dwordx4 v241, s[28:31], s45 offen offset:1088 lds
    v_mfma_f32_16x16x32_bf16 v[44:47], a[140:143], v[156:159], v[44:47]
    ds_read_b128 a[128:131], v101 offset:0
    v_mov_b32_dpp v15, v191 row_ror:8 row_mask:0xf bank_mask:0xf
    v_mfma_f32_16x16x32_bf16 v[40:43], a[140:143], v[152:155], v[40:43]
    v_perm_b32 v171, v14, v190, v4
    v_perm_b32 v175, v15, v191, v4
    v_mfma_f32_16x16x32_bf16 v[40:43], a[136:139], v[232:235], v[40:43]
    v_mov_b32_dpp v12, v192 row_ror:8 row_mask:0xf bank_mask:0xf
    v_mov_b32_dpp v13, v193 row_ror:8 row_mask:0xf bank_mask:0xf
    v_mfma_f32_16x16x32_bf16 v[36:39], a[136:139], v[228:231], v[36:39]
    buffer_load_dwordx4 v242, s[28:31], s46 offen offset:2176 lds
    v_mfma_f32_16x16x32_bf16 v[36:39], a[140:143], v[148:151], v[36:39]
    ds_read_b128 a[132:135], v101 offset:16
    v_perm_b32 v176, v12, v192, v4
    v_mfma_f32_16x16x32_bf16 v[32:35], a[140:143], v[144:147], v[32:35]
    v_perm_b32 v180, v13, v193, v4
    v_mov_b32_dpp v14, v194 row_ror:8 row_mask:0xf bank_mask:0xf
    v_mfma_f32_16x16x32_bf16 v[32:35], a[136:139], v[224:227], v[32:35]
    s_waitcnt vmcnt(11)
    v_mov_b32_dpp v15, v195 row_ror:8 row_mask:0xf bank_mask:0xf
    v_perm_b32 v184, v14, v194, v4
    v_mfma_f32_16x16x32_bf16 a[0:3], v[144:147], a[144:147], a[0:3]
    buffer_load_dwordx4 v243, s[28:31], 0 offen offset:3264 lds
    v_mfma_f32_16x16x32_bf16 a[0:3], v[160:163], a[148:151], a[0:3]
    ds_read_b128 a[136:139], v103 offset:0
    v_perm_b32 v188, v15, v195, v4
    v_mfma_f32_16x16x32_bf16 a[4:7], v[164:167], a[148:151], a[4:7]
    ds_read_b128 a[160:163], v143 offset:0
    v_mov_b32_dpp v12, v196 row_ror:8 row_mask:0xf bank_mask:0xf
    v_mfma_f32_16x16x32_bf16 a[4:7], v[148:151], a[144:147], a[4:7]
    ds_read_b128 a[164:167], v143 offset:64
    v_mov_b32_dpp v13, v197 row_ror:8 row_mask:0xf bank_mask:0xf
    v_mfma_f32_16x16x32_bf16 a[8:11], v[152:155], a[144:147], a[8:11]
    buffer_load_dwordx4 v[48:51], v2, s[32:35], s71 offen offset:0
    v_mfma_f32_16x16x32_bf16 a[8:11], v[168:171], a[148:151], a[8:11]
    ds_read_b128 a[140:143], v103 offset:16
    v_perm_b32 v177, v12, v196, v4
    v_mfma_f32_16x16x32_bf16 a[12:15], v[172:175], a[148:151], a[12:15]
    ds_read_b128 v[136:139], v141 offset:192
    v_perm_b32 v181, v13, v197, v4
    v_mfma_f32_16x16x32_bf16 a[12:15], v[156:159], a[144:147], a[12:15]
    s_waitcnt lgkmcnt(14)
    ds_read_b128 a[168:171], v143 offset:128
    v_mov_b32_dpp v14, v198 row_ror:8 row_mask:0xf bank_mask:0xf
    v_mfma_f32_16x16x32_bf16 a[28:31], v[156:159], a[152:155], a[28:31]
    buffer_load_dwordx4 v[52:55], v2, s[32:35], s71 offen offset:2048
    v_mfma_f32_16x16x32_bf16 a[28:31], v[172:175], a[156:159], a[28:31]
    ds_read_b128 a[144:147], v96 offset:16
    v_mov_b32_dpp v15, v199 row_ror:8 row_mask:0xf bank_mask:0xf
    v_mfma_f32_16x16x32_bf16 a[24:27], v[168:171], a[156:159], a[24:27]
    ds_read_b128 a[172:175], v143 offset:192
    v_perm_b32 v185, v14, v198, v4
    v_mfma_f32_16x16x32_bf16 a[24:27], v[152:155], a[152:155], a[24:27]
    v_perm_b32 v189, v15, v199, v4
    v_mov_b32_dpp v12, v200 row_ror:8 row_mask:0xf bank_mask:0xf
    v_mfma_f32_16x16x32_bf16 a[20:23], v[148:151], a[152:155], a[20:23]
    buffer_load_dwordx4 v[56:59], v3, s[32:35], s71 offen offset:0
    v_mfma_f32_16x16x32_bf16 a[20:23], v[164:167], a[156:159], a[20:23]
    ds_read_b128 a[148:151], v96 offset:32
    v_mov_b32_dpp v13, v201 row_ror:8 row_mask:0xf bank_mask:0xf
    v_mfma_f32_16x16x32_bf16 a[16:19], v[160:163], a[156:159], a[16:19]
    v_perm_b32 v178, v12, v200, v4
    v_perm_b32 v182, v13, v201, v4
    v_mfma_f32_16x16x32_bf16 a[16:19], v[144:147], a[152:155], a[16:19]
    s_waitcnt vmcnt(11) lgkmcnt(4)
    v_mov_b32_dpp v14, v202 row_ror:8 row_mask:0xf bank_mask:0xf
    v_mov_b32_dpp v15, v203 row_ror:8 row_mask:0xf bank_mask:0xf
    v_mfma_f32_16x16x32_bf16 a[32:35], a[96:99], v[144:147], a[32:35]
    buffer_load_dwordx4 v[60:63], v3, s[32:35], s71 offen offset:2048
    v_mfma_f32_16x16x32_bf16 a[32:35], a[100:103], v[160:163], a[32:35]
    ds_read_b128 a[152:155], v97 offset:16
    v_lshl_add_u32 v136, v136, 8, v11
    v_mfma_f32_16x16x32_bf16 a[36:39], a[100:103], v[164:167], a[36:39]
    v_lshl_add_u32 v137, v137, 8, v11
    v_lshl_add_u32 v138, v138, 8, v11
    v_mfma_f32_16x16x32_bf16 a[36:39], a[96:99], v[148:151], a[36:39]
    ds_read_b128 a[176:179], v143 offset:17408
    v_lshl_add_u32 v139, v139, 8, v11
    v_mfma_f32_16x16x32_bf16 a[40:43], a[96:99], v[152:155], a[40:43]
    buffer_load_dwordx4 v[64:67], v2, s[32:35], s72 offen offset:0
    v_mfma_f32_16x16x32_bf16 a[40:43], a[100:103], v[168:171], a[40:43]
    ds_read_b128 a[156:159], v97 offset:32
    v_perm_b32 v186, v14, v202, v4
    v_mfma_f32_16x16x32_bf16 a[44:47], a[100:103], v[172:175], a[44:47]
    ds_read_b128 a[180:183], v143 offset:17472
    v_perm_b32 v190, v15, v203, v4
    v_mfma_f32_16x16x32_bf16 a[44:47], a[96:99], v[156:159], a[44:47]
    s_waitcnt vmcnt(12)
    ds_read_b128 a[184:187], v143 offset:17536
    v_mov_b32_dpp v12, v204 row_ror:8 row_mask:0xf bank_mask:0xf
    v_mfma_f32_16x16x32_bf16 v[28:31], a[104:107], v[156:159], v[28:31]
    buffer_load_dwordx4 v[68:71], v2, s[32:35], s72 offen offset:2048
    v_mfma_f32_16x16x32_bf16 v[28:31], a[108:111], v[172:175], v[28:31]
    ds_read_b128 a[96:99], v98 offset:16
    v_mov_b32_dpp v13, v205 row_ror:8 row_mask:0xf bank_mask:0xf
    v_mfma_f32_16x16x32_bf16 v[24:27], a[108:111], v[168:171], v[24:27]
    ds_read_b128 a[188:191], v143 offset:17600
    v_perm_b32 v179, v12, v204, v4
    v_mfma_f32_16x16x32_bf16 v[24:27], a[104:107], v[152:155], v[24:27]
    v_perm_b32 v183, v13, v205, v4
    v_mov_b32_dpp v14, v206 row_ror:8 row_mask:0xf bank_mask:0xf
    v_mfma_f32_16x16x32_bf16 v[20:23], a[104:107], v[148:151], v[20:23]
    buffer_load_dwordx4 v[72:75], v3, s[32:35], s72 offen offset:0
    v_mfma_f32_16x16x32_bf16 v[20:23], a[108:111], v[164:167], v[20:23]
    ds_read_b128 a[100:103], v98 offset:32
    v_mov_b32_dpp v15, v207 row_ror:8 row_mask:0xf bank_mask:0xf
    v_mfma_f32_16x16x32_bf16 v[16:19], a[108:111], v[160:163], v[16:19]
    v_perm_b32 v187, v14, v206, v4
    v_perm_b32 v191, v15, v207, v4
    v_mfma_f32_16x16x32_bf16 v[16:19], a[104:107], v[144:147], v[16:19]
    s_waitcnt vmcnt(13)
    v_mov_b32_dpp v12, v208 row_ror:8 row_mask:0xf bank_mask:0xf
    v_mov_b32_dpp v13, v209 row_ror:8 row_mask:0xf bank_mask:0xf
    v_mfma_f32_16x16x32_bf16 a[48:51], a[112:115], v[160:163], a[48:51]
    buffer_load_dwordx4 v[76:79], v3, s[32:35], s72 offen offset:2048
    v_mfma_f32_16x16x32_bf16 a[48:51], a[116:119], v[176:179], a[48:51]
    ds_read_b128 a[104:107], v102 offset:16
    v_perm_b32 v192, v12, v208, v4
    v_mfma_f32_16x16x32_bf16 a[52:55], a[116:119], v[180:183], a[52:55]
    v_perm_b32 v196, v13, v209, v4
    v_mov_b32_dpp v14, v210 row_ror:8 row_mask:0xf bank_mask:0xf
    v_mfma_f32_16x16x32_bf16 a[52:55], a[112:115], v[164:167], a[52:55]
    v_mov_b32_dpp v15, v211 row_ror:8 row_mask:0xf bank_mask:0xf
    v_perm_b32 v200, v14, v210, v4
    v_mfma_f32_16x16x32_bf16 a[56:59], a[112:115], v[168:171], a[56:59]
    buffer_load_dwordx4 v[224:227], v2, s[32:35], s73 offen offset:0
    v_mfma_f32_16x16x32_bf16 a[56:59], a[116:119], v[184:187], a[56:59]
    s_add_u32 m0, s3, 0
    ds_read_b128 a[108:111], v102 offset:32
    v_perm_b32 v204, v15, v211, v4
    v_mfma_f32_16x16x32_bf16 a[60:63], a[116:119], v[188:191], a[60:63]
    v_mov_b32_dpp v12, v212 row_ror:8 row_mask:0xf bank_mask:0xf
    v_mov_b32_dpp v13, v213 row_ror:8 row_mask:0xf bank_mask:0xf
    v_mfma_f32_16x16x32_bf16 a[60:63], a[112:115], v[172:175], a[60:63]
    s_waitcnt vmcnt(14)
    v_perm_b32 v193, v12, v212, v4
    v_perm_b32 v197, v13, v213, v4
    v_mfma_f32_16x16x32_bf16 a[76:79], a[120:123], v[172:175], a[76:79]
    buffer_load_dwordx4 v[228:231], v2, s[32:35], s73 offen offset:2048
    v_mfma_f32_16x16x32_bf16 a[76:79], a[124:127], v[188:191], a[76:79]
    ds_read_b128 a[112:115], v99 offset:32
    v_mov_b32_dpp v14, v214 row_ror:8 row_mask:0xf bank_mask:0xf
    v_mfma_f32_16x16x32_bf16 a[72:75], a[124:127], v[184:187], a[72:75]
    v_mov_b32_dpp v15, v215 row_ror:8 row_mask:0xf bank_mask:0xf
    v_perm_b32 v201, v14, v214, v4
    v_mfma_f32_16x16x32_bf16 a[72:75], a[120:123], v[168:171], a[72:75]
    v_perm_b32 v205, v15, v215, v4
    v_mov_b32_dpp v12, v216 row_ror:8 row_mask:0xf bank_mask:0xf
    v_mfma_f32_16x16x32_bf16 a[68:71], a[120:123], v[164:167], a[68:71]
    buffer_load_dwordx4 v[232:235], v3, s[32:35], s73 offen offset:0
    v_mfma_f32_16x16x32_bf16 a[68:71], a[124:127], v[180:183], a[68:71]
    ds_read_b128 a[116:119], v99 offset:48
    v_mov_b32_dpp v13, v217 row_ror:8 row_mask:0xf bank_mask:0xf
    v_mfma_f32_16x16x32_bf16 a[64:67], a[124:127], v[176:179], a[64:67]
    v_perm_b32 v194, v12, v216, v4
    v_perm_b32 v198, v13, v217, v4
    v_mfma_f32_16x16x32_bf16 a[64:67], a[120:123], v[160:163], a[64:67]
    s_waitcnt vmcnt(11) lgkmcnt(13)
    v_mov_b32_dpp v14, v218 row_ror:8 row_mask:0xf bank_mask:0xf
    v_mov_b32_dpp v15, v219 row_ror:8 row_mask:0xf bank_mask:0xf
    v_mfma_f32_16x16x32_bf16 a[80:83], a[128:131], v[160:163], a[80:83]
    buffer_load_dwordx4 v[236:239], v3, s[32:35], s73 offen offset:2048
    v_mfma_f32_16x16x32_bf16 a[80:83], a[132:135], v[176:179], a[80:83]
    ds_read_b128 a[120:123], v100 offset:32
    v_perm_b32 v202, v14, v218, v4
    v_mfma_f32_16x16x32_bf16 a[84:87], a[132:135], v[180:183], a[84:87]
    ds_read_b128 a[192:195], v143 offset:34816
    v_perm_b32 v206, v15, v219, v4
    v_mfma_f32_16x16x32_bf16 a[84:87], a[128:131], v[164:167], a[84:87]
    ds_read_b128 a[196:199], v143 offset:34880
    v_mov_b32_dpp v12, v220 row_ror:8 row_mask:0xf bank_mask:0xf
    v_mfma_f32_16x16x32_bf16 a[88:91], a[128:131], v[168:171], a[88:91]
    buffer_load_dwordx4 v136, s[28:31], s44 offen offset:0 lds
    v_mfma_f32_16x16x32_bf16 a[88:91], a[132:135], v[184:187], a[88:91]
    ds_read_b128 a[124:127], v100 offset:48
    v_mov_b32_dpp v13, v221 row_ror:8 row_mask:0xf bank_mask:0xf
    v_mfma_f32_16x16x32_bf16 a[92:95], a[132:135], v[188:191], a[92:95]
    ds_read_b32 v142, v142 offset:384
    v_perm_b32 v195, v12, v220, v4
    v_mfma_f32_16x16x32_bf16 a[92:95], a[128:131], v[172:175], a[92:95]
    s_waitcnt vmcnt(12)
    ds_read_b128 a[200:203], v143 offset:34944
    v_perm_b32 v199, v13, v221, v4
    v_mfma_f32_16x16x32_bf16 v[44:47], a[136:139], v[172:175], v[44:47]
    buffer_load_dwordx4 v137, s[28:31], s45 offen offset:1088 lds
    v_mfma_f32_16x16x32_bf16 v[44:47], a[140:143], v[188:191], v[44:47]
    ds_read_b128 a[128:131], v101 offset:32
    v_mov_b32_dpp v14, v222 row_ror:8 row_mask:0xf bank_mask:0xf
    v_mfma_f32_16x16x32_bf16 v[40:43], a[140:143], v[184:187], v[40:43]
    ds_read_b128 a[204:207], v143 offset:35008
    v_mov_b32_dpp v15, v223 row_ror:8 row_mask:0xf bank_mask:0xf
    v_mfma_f32_16x16x32_bf16 v[40:43], a[136:139], v[168:171], v[40:43]
    v_perm_b32 v203, v14, v222, v4
    v_perm_b32 v207, v15, v223, v4
    v_mfma_f32_16x16x32_bf16 v[36:39], a[136:139], v[164:167], v[36:39]
    buffer_load_dwordx4 v138, s[28:31], s46 offen offset:2176 lds
    v_mfma_f32_16x16x32_bf16 v[36:39], a[140:143], v[180:183], v[36:39]
    ds_read_b128 a[132:135], v101 offset:48
    v_mov_b32_dpp v12, v48 row_ror:8 row_mask:0xf bank_mask:0xf
    v_mfma_f32_16x16x32_bf16 v[32:35], a[140:143], v[176:179], v[32:35]
    v_mov_b32_dpp v13, v49 row_ror:8 row_mask:0xf bank_mask:0xf
    v_perm_b32 v208, v12, v48, v4
    v_mfma_f32_16x16x32_bf16 v[32:35], a[136:139], v[160:163], v[32:35]
    s_waitcnt vmcnt(13) lgkmcnt(4)
    v_perm_b32 v212, v13, v49, v4
    v_mov_b32_dpp v14, v50 row_ror:8 row_mask:0xf bank_mask:0xf
    v_mfma_f32_16x16x32_bf16 a[0:3], v[176:179], a[144:147], a[0:3]
    buffer_load_dwordx4 v139, s[28:31], 0 offen offset:3264 lds
    v_mfma_f32_16x16x32_bf16 a[0:3], v[192:195], a[148:151], a[0:3]
    ds_read_b128 a[136:139], v103 offset:32
    v_lshl_add_u32 v142, v142, 8, v11
    v_mfma_f32_16x16x32_bf16 a[4:7], v[196:199], a[148:151], a[4:7]
    v_mov_b32_dpp v15, v51 row_ror:8 row_mask:0xf bank_mask:0xf
    v_perm_b32 v216, v14, v50, v4
    v_mfma_f32_16x16x32_bf16 a[4:7], v[180:183], a[144:147], a[4:7]
    v_perm_b32 v220, v15, v51, v4
    v_mov_b32_dpp v12, v52 row_ror:8 row_mask:0xf bank_mask:0xf
    v_mfma_f32_16x16x32_bf16 a[8:11], v[184:187], a[144:147], a[8:11]
    buffer_load_dwordx4 v[144:147], v2, s[32:35], s74 offen offset:0
    v_mfma_f32_16x16x32_bf16 a[8:11], v[200:203], a[148:151], a[8:11]
    ds_read_b128 a[140:143], v103 offset:48
    v_mov_b32_dpp v13, v53 row_ror:8 row_mask:0xf bank_mask:0xf
    v_mfma_f32_16x16x32_bf16 a[12:15], v[204:207], a[148:151], a[12:15]
    v_perm_b32 v209, v12, v52, v4
    v_perm_b32 v213, v13, v53, v4
    v_mfma_f32_16x16x32_bf16 a[12:15], v[188:191], a[144:147], a[12:15]
    s_waitcnt vmcnt(14)
    v_mov_b32_dpp v14, v54 row_ror:8 row_mask:0xf bank_mask:0xf
    v_mov_b32_dpp v15, v55 row_ror:8 row_mask:0xf bank_mask:0xf
    v_mfma_f32_16x16x32_bf16 a[28:31], v[188:191], a[152:155], a[28:31]
    buffer_load_dwordx4 v[148:151], v2, s[32:35], s74 offen offset:2048
    v_mfma_f32_16x16x32_bf16 a[28:31], v[204:207], a[156:159], a[28:31]
    ds_read_b128 a[144:147], v96 offset:48
    v_perm_b32 v217, v14, v54, v4
    v_mfma_f32_16x16x32_bf16 a[24:27], v[200:203], a[156:159], a[24:27]
    v_perm_b32 v221, v15, v55, v4
    v_mov_b32_dpp v12, v56 row_ror:8 row_mask:0xf bank_mask:0xf
    v_mfma_f32_16x16x32_bf16 a[24:27], v[184:187], a[152:155], a[24:27]
    v_mov_b32_dpp v13, v57 row_ror:8 row_mask:0xf bank_mask:0xf
    v_perm_b32 v210, v12, v56, v4
    v_mfma_f32_16x16x32_bf16 a[20:23], v[180:183], a[152:155], a[20:23]
    buffer_load_dwordx4 v[152:155], v3, s[32:35], s74 offen offset:0
    v_mfma_f32_16x16x32_bf16 a[20:23], v[196:199], a[156:159], a[20:23]
    ds_read_b128 a[148:151], v104 offset:0
    v_perm_b32 v214, v13, v57, v4
    v_mfma_f32_16x16x32_bf16 a[16:19], v[192:195], a[156:159], a[16:19]
    v_mov_b32_dpp v14, v58 row_ror:8 row_mask:0xf bank_mask:0xf
    v_mov_b32_dpp v15, v59 row_ror:8 row_mask:0xf bank_mask:0xf
    v_mfma_f32_16x16x32_bf16 a[16:19], v[176:179], a[152:155], a[16:19]
    s_waitcnt vmcnt(14)
    v_perm_b32 v218, v14, v58, v4
    v_perm_b32 v222, v15, v59, v4
    v_mfma_f32_16x16x32_bf16 a[32:35], a[96:99], v[176:179], a[32:35]
    buffer_load_dwordx4 v[156:159], v3, s[32:35], s74 offen offset:2048
    v_mfma_f32_16x16x32_bf16 a[32:35], a[100:103], v[192:195], a[32:35]
    ds_read_b128 a[152:155], v97 offset:48
    v_mov_b32_dpp v12, v60 row_ror:8 row_mask:0xf bank_mask:0xf
    v_mfma_f32_16x16x32_bf16 a[36:39], a[100:103], v[196:199], a[36:39]
    v_mov_b32_dpp v13, v61 row_ror:8 row_mask:0xf bank_mask:0xf
    v_perm_b32 v211, v12, v60, v4
    v_mfma_f32_16x16x32_bf16 a[36:39], a[96:99], v[180:183], a[36:39]
    v_perm_b32 v215, v13, v61, v4
    v_mov_b32_dpp v14, v62 row_ror:8 row_mask:0xf bank_mask:0xf
    v_mfma_f32_16x16x32_bf16 a[40:43], a[96:99], v[184:187], a[40:43]
    buffer_load_dwordx4 v[160:163], v2, s[32:35], s75 offen offset:0
    v_mfma_f32_16x16x32_bf16 a[40:43], a[100:103], v[200:203], a[40:43]
    s_mov_b32 m0, s50
    ds_read_b128 a[156:159], v105 offset:0
    v_mov_b32_dpp v15, v63 row_ror:8 row_mask:0xf bank_mask:0xf
    v_mfma_f32_16x16x32_bf16 a[44:47], a[100:103], v[204:207], a[44:47]
    v_perm_b32 v219, v14, v62, v4
    v_perm_b32 v223, v15, v63, v4
    v_mfma_f32_16x16x32_bf16 a[44:47], a[96:99], v[188:191], a[44:47]
    s_waitcnt vmcnt(15)
    v_mov_b32_dpp v12, v64 row_ror:8 row_mask:0xf bank_mask:0xf
    v_mov_b32_dpp v13, v65 row_ror:8 row_mask:0xf bank_mask:0xf
    v_mfma_f32_16x16x32_bf16 v[28:31], a[104:107], v[188:191], v[28:31]
    buffer_load_dwordx4 v[164:167], v2, s[32:35], s75 offen offset:2048
    v_mfma_f32_16x16x32_bf16 v[28:31], a[108:111], v[204:207], v[28:31]
    ds_read_b128 a[96:99], v98 offset:48
    v_perm_b32 v48, v12, v64, v4
    v_mfma_f32_16x16x32_bf16 v[24:27], a[108:111], v[200:203], v[24:27]
    v_perm_b32 v52, v13, v65, v4
    v_mov_b32_dpp v14, v66 row_ror:8 row_mask:0xf bank_mask:0xf
    v_mfma_f32_16x16x32_bf16 v[24:27], a[104:107], v[184:187], v[24:27]
    v_mov_b32_dpp v15, v67 row_ror:8 row_mask:0xf bank_mask:0xf
    v_perm_b32 v56, v14, v66, v4
    v_mfma_f32_16x16x32_bf16 v[20:23], a[104:107], v[180:183], v[20:23]
    buffer_load_dwordx4 v[168:171], v3, s[32:35], s75 offen offset:0
    v_mfma_f32_16x16x32_bf16 v[20:23], a[108:111], v[196:199], v[20:23]
    ds_read_b128 a[100:103], v106 offset:0
    v_perm_b32 v60, v15, v67, v4
    v_mfma_f32_16x16x32_bf16 v[16:19], a[108:111], v[192:195], v[16:19]
    v_mov_b32_dpp v12, v68 row_ror:8 row_mask:0xf bank_mask:0xf
    v_mov_b32_dpp v13, v69 row_ror:8 row_mask:0xf bank_mask:0xf
    v_mfma_f32_16x16x32_bf16 v[16:19], a[104:107], v[176:179], v[16:19]
    s_waitcnt vmcnt(16)
    v_perm_b32 v49, v12, v68, v4
    v_perm_b32 v53, v13, v69, v4
    v_mfma_f32_16x16x32_bf16 a[48:51], a[112:115], v[192:195], a[48:51]
    buffer_load_dwordx4 v[172:175], v3, s[32:35], s75 offen offset:2048
    v_mfma_f32_16x16x32_bf16 a[48:51], a[116:119], v[208:211], a[48:51]
    ds_read_b128 a[104:107], v102 offset:48
    v_mov_b32_dpp v14, v70 row_ror:8 row_mask:0xf bank_mask:0xf
    v_mfma_f32_16x16x32_bf16 a[52:55], a[116:119], v[212:215], a[52:55]
    v_mov_b32_dpp v15, v71 row_ror:8 row_mask:0xf bank_mask:0xf
    v_perm_b32 v57, v14, v70, v4
    v_mfma_f32_16x16x32_bf16 a[52:55], a[112:115], v[196:199], a[52:55]
    v_perm_b32 v61, v15, v71, v4
    v_mov_b32_dpp v12, v72 row_ror:8 row_mask:0xf bank_mask:0xf
    v_mfma_f32_16x16x32_bf16 a[56:59], a[112:115], v[200:203], a[56:59]
    buffer_load_dwordx4 v142, s[28:31], s44 offen offset:0 lds
    v_mfma_f32_16x16x32_bf16 a[56:59], a[116:119], v[216:219], a[56:59]
    ds_read_b128 a[108:111], v110 offset:0
    v_mov_b32_dpp v13, v73 row_ror:8 row_mask:0xf bank_mask:0xf
    v_mfma_f32_16x16x32_bf16 a[60:63], a[116:119], v[220:223], a[60:63]
    v_perm_b32 v50, v12, v72, v4
    v_perm_b32 v54, v13, v73, v4
    v_mfma_f32_16x16x32_bf16 a[60:63], a[112:115], v[204:207], a[60:63]
    s_waitcnt vmcnt(17)
    v_mov_b32_dpp v14, v74 row_ror:8 row_mask:0xf bank_mask:0xf
    v_mov_b32_dpp v15, v75 row_ror:8 row_mask:0xf bank_mask:0xf
    v_mfma_f32_16x16x32_bf16 a[76:79], a[120:123], v[204:207], a[76:79]
    buffer_load_dwordx4 v[176:179], v2, s[32:35], s76 offen offset:0
    v_mfma_f32_16x16x32_bf16 a[76:79], a[124:127], v[220:223], a[76:79]
    ds_read_b128 a[112:115], v107 offset:0
    v_perm_b32 v58, v14, v74, v4
    v_mfma_f32_16x16x32_bf16 a[72:75], a[124:127], v[216:219], a[72:75]
    v_perm_b32 v62, v15, v75, v4
    v_mov_b32_dpp v12, v76 row_ror:8 row_mask:0xf bank_mask:0xf
    v_mfma_f32_16x16x32_bf16 a[72:75], a[120:123], v[200:203], a[72:75]
    v_mov_b32_dpp v13, v77 row_ror:8 row_mask:0xf bank_mask:0xf
    v_perm_b32 v51, v12, v76, v4
    v_mfma_f32_16x16x32_bf16 a[68:71], a[120:123], v[196:199], a[68:71]
    buffer_load_dwordx4 v[180:183], v2, s[32:35], s76 offen offset:2048
    v_mfma_f32_16x16x32_bf16 a[68:71], a[124:127], v[212:215], a[68:71]
    ds_read_b128 a[116:119], v107 offset:16
    v_perm_b32 v55, v13, v77, v4
    v_mfma_f32_16x16x32_bf16 a[64:67], a[124:127], v[208:211], a[64:67]
    v_mov_b32_dpp v14, v78 row_ror:8 row_mask:0xf bank_mask:0xf
    v_mov_b32_dpp v15, v79 row_ror:8 row_mask:0xf bank_mask:0xf
    v_mfma_f32_16x16x32_bf16 a[64:67], a[120:123], v[192:195], a[64:67]
    s_waitcnt vmcnt(11) lgkmcnt(12)
    v_perm_b32 v59, v14, v78, v4
    v_perm_b32 v63, v15, v79, v4
    v_mfma_f32_16x16x32_bf16 a[80:83], a[128:131], v[192:195], a[80:83]
    buffer_load_dwordx4 v[184:187], v3, s[32:35], s76 offen offset:0
    v_mfma_f32_16x16x32_bf16 a[80:83], a[132:135], v[208:211], a[80:83]
    ds_read_b128 a[120:123], v108 offset:0
    v_mov_b32_dpp v12, v224 row_ror:8 row_mask:0xf bank_mask:0xf
    v_mfma_f32_16x16x32_bf16 a[84:87], a[132:135], v[212:215], a[84:87]
    ds_read_b128 a[208:211], v143 offset:0
    v_mov_b32_dpp v13, v225 row_ror:8 row_mask:0xf bank_mask:0xf
    v_mfma_f32_16x16x32_bf16 a[84:87], a[128:131], v[196:199], a[84:87]
    ds_read_b128 a[212:215], v143 offset:64
    v_perm_b32 v64, v12, v224, v4
    v_mfma_f32_16x16x32_bf16 a[88:91], a[128:131], v[200:203], a[88:91]
    buffer_load_dwordx4 v[188:191], v3, s[32:35], s76 offen offset:2048
    v_mfma_f32_16x16x32_bf16 a[88:91], a[132:135], v[216:219], a[88:91]
    ds_read_b128 a[124:127], v108 offset:16
    v_perm_b32 v68, v13, v225, v4
    v_mfma_f32_16x16x32_bf16 a[92:95], a[132:135], v[220:223], a[92:95]
    ds_read_b128 a[216:219], v143 offset:128
    v_mov_b32_dpp v14, v226 row_ror:8 row_mask:0xf bank_mask:0xf
    v_mfma_f32_16x16x32_bf16 a[92:95], a[128:131], v[204:207], a[92:95]
    s_waitcnt lgkmcnt(14)
    ds_read_b128 a[220:223], v143 offset:192
    v_mov_b32_dpp v15, v227 row_ror:8 row_mask:0xf bank_mask:0xf
    v_mfma_f32_16x16x32_bf16 v[44:47], a[136:139], v[204:207], v[44:47]
    v_perm_b32 v72, v14, v226, v4
    v_perm_b32 v76, v15, v227, v4
    v_mfma_f32_16x16x32_bf16 v[44:47], a[140:143], v[220:223], v[44:47]
    ds_read_b128 a[128:131], v109 offset:0
    v_mov_b32_dpp v12, v228 row_ror:8 row_mask:0xf bank_mask:0xf
    v_mfma_f32_16x16x32_bf16 v[40:43], a[140:143], v[216:219], v[40:43]
    v_mov_b32_dpp v13, v229 row_ror:8 row_mask:0xf bank_mask:0xf
    v_perm_b32 v65, v12, v228, v4
    v_mfma_f32_16x16x32_bf16 v[40:43], a[136:139], v[200:203], v[40:43]
    v_perm_b32 v69, v13, v229, v4
    v_mov_b32_dpp v14, v230 row_ror:8 row_mask:0xf bank_mask:0xf
    v_mfma_f32_16x16x32_bf16 v[36:39], a[136:139], v[196:199], v[36:39]
    v_mov_b32_dpp v15, v231 row_ror:8 row_mask:0xf bank_mask:0xf
    v_perm_b32 v73, v14, v230, v4
    v_mfma_f32_16x16x32_bf16 v[36:39], a[140:143], v[212:215], v[36:39]
    ds_read_b128 a[132:135], v109 offset:16
    v_perm_b32 v77, v15, v231, v4
    v_mfma_f32_16x16x32_bf16 v[32:35], a[140:143], v[208:211], v[32:35]
    v_mov_b32_dpp v12, v232 row_ror:8 row_mask:0xf bank_mask:0xf
    v_mov_b32_dpp v13, v233 row_ror:8 row_mask:0xf bank_mask:0xf
    v_mfma_f32_16x16x32_bf16 v[32:35], a[136:139], v[192:195], v[32:35]
    s_waitcnt lgkmcnt(14)
    v_perm_b32 v66, v12, v232, v4
    v_perm_b32 v70, v13, v233, v4
    v_mfma_f32_16x16x32_bf16 a[0:3], v[208:211], a[144:147], a[0:3]
    buffer_load_dwordx4 v[192:195], v250, s[32:35], s84 offen offset:0
    v_mfma_f32_16x16x32_bf16 a[0:3], v[48:51], a[148:151], a[0:3]
    ds_read_b128 a[136:139], v111 offset:0
    v_mov_b32_dpp v14, v234 row_ror:8 row_mask:0xf bank_mask:0xf
    v_mfma_f32_16x16x32_bf16 a[4:7], v[52:55], a[148:151], a[4:7]
    v_mov_b32_dpp v15, v235 row_ror:8 row_mask:0xf bank_mask:0xf
    v_perm_b32 v74, v14, v234, v4
    v_mfma_f32_16x16x32_bf16 a[4:7], v[212:215], a[144:147], a[4:7]
    v_perm_b32 v78, v15, v235, v4
    v_mov_b32_dpp v12, v236 row_ror:8 row_mask:0xf bank_mask:0xf
    v_mfma_f32_16x16x32_bf16 a[8:11], v[216:219], a[144:147], a[8:11]
    buffer_load_dwordx4 v[196:199], v250, s[32:35], s84 offen offset:2048
    v_mfma_f32_16x16x32_bf16 a[8:11], v[56:59], a[148:151], a[8:11]
    ds_read_b128 a[140:143], v111 offset:16
    v_mov_b32_dpp v13, v237 row_ror:8 row_mask:0xf bank_mask:0xf
    v_mfma_f32_16x16x32_bf16 a[12:15], v[60:63], a[148:151], a[12:15]
    v_perm_b32 v67, v12, v236, v4
    v_perm_b32 v71, v13, v237, v4
    v_mfma_f32_16x16x32_bf16 a[12:15], v[220:223], a[144:147], a[12:15]
    s_waitcnt vmcnt(14)
    v_mov_b32_dpp v14, v238 row_ror:8 row_mask:0xf bank_mask:0xf
    v_mov_b32_dpp v15, v239 row_ror:8 row_mask:0xf bank_mask:0xf
    v_mfma_f32_16x16x32_bf16 a[28:31], v[220:223], a[152:155], a[28:31]
    buffer_load_dwordx4 v[200:203], v251, s[32:35], s84 offen offset:0
    v_mfma_f32_16x16x32_bf16 a[28:31], v[60:63], a[156:159], a[28:31]
    ds_read_b128 a[144:147], v104 offset:16
    v_perm_b32 v75, v14, v238, v4
    v_mfma_f32_16x16x32_bf16 a[24:27], v[56:59], a[156:159], a[24:27]
    v_perm_b32 v79, v15, v239, v4
    v_mov_b32_dpp v12, v144 row_ror:8 row_mask:0xf bank_mask:0xf
    v_mfma_f32_16x16x32_bf16 a[24:27], v[216:219], a[152:155], a[24:27]
    v_mov_b32_dpp v13, v145 row_ror:8 row_mask:0xf bank_mask:0xf
    v_perm_b32 v224, v12, v144, v4
    v_mfma_f32_16x16x32_bf16 a[20:23], v[212:215], a[152:155], a[20:23]
    buffer_load_dwordx4 v[204:207], v251, s[32:35], s84 offen offset:2048
    v_mfma_f32_16x16x32_bf16 a[20:23], v[52:55], a[156:159], a[20:23]
    ds_read_b128 a[148:151], v104 offset:32
    v_perm_b32 v228, v13, v145, v4
    v_mfma_f32_16x16x32_bf16 a[16:19], v[48:51], a[156:159], a[16:19]
    v_mov_b32_dpp v14, v146 row_ror:8 row_mask:0xf bank_mask:0xf
    v_mov_b32_dpp v15, v147 row_ror:8 row_mask:0xf bank_mask:0xf
    v_mfma_f32_16x16x32_bf16 a[16:19], v[208:211], a[152:155], a[16:19]
    s_waitcnt vmcnt(14) lgkmcnt(14)
    v_perm_b32 v232, v14, v146, v4
    v_perm_b32 v236, v15, v147, v4
    v_mfma_f32_16x16x32_bf16 a[32:35], a[96:99], v[208:211], a[32:35]
    v_mov_b32_dpp v12, v148 row_ror:8 row_mask:0xf bank_mask:0xf
    v_mov_b32_dpp v13, v149 row_ror:8 row_mask:0xf bank_mask:0xf
    v_mfma_f32_16x16x32_bf16 a[32:35], a[100:103], v[48:51], a[32:35]
    ds_read_b128 a[152:155], v105 offset:16
    v_perm_b32 v225, v12, v148, v4
    v_mfma_f32_16x16x32_bf16 a[36:39], a[100:103], v[52:55], a[36:39]
    v_perm_b32 v229, v13, v149, v4
    v_mov_b32_dpp v14, v150 row_ror:8 row_mask:0xf bank_mask:0xf
    v_mfma_f32_16x16x32_bf16 a[36:39], a[96:99], v[212:215], a[36:39]
    v_mov_b32_dpp v15, v151 row_ror:8 row_mask:0xf bank_mask:0xf
    v_perm_b32 v233, v14, v150, v4
    v_mfma_f32_16x16x32_bf16 a[40:43], a[96:99], v[216:219], a[40:43]
    v_perm_b32 v237, v15, v151, v4
    v_mov_b32_dpp v12, v152 row_ror:8 row_mask:0xf bank_mask:0xf
    v_mfma_f32_16x16x32_bf16 a[40:43], a[100:103], v[56:59], a[40:43]
    ds_read_b128 a[156:159], v105 offset:32
    v_mov_b32_dpp v13, v153 row_ror:8 row_mask:0xf bank_mask:0xf
    v_mfma_f32_16x16x32_bf16 a[44:47], a[100:103], v[60:63], a[44:47]
    v_perm_b32 v226, v12, v152, v4
    v_perm_b32 v230, v13, v153, v4
    v_mfma_f32_16x16x32_bf16 a[44:47], a[96:99], v[220:223], a[44:47]
    s_waitcnt vmcnt(12)
    v_mov_b32_dpp v14, v154 row_ror:8 row_mask:0xf bank_mask:0xf
    v_mov_b32_dpp v15, v155 row_ror:8 row_mask:0xf bank_mask:0xf
    v_mfma_f32_16x16x32_bf16 v[28:31], a[104:107], v[220:223], v[28:31]
    ds_read_b128 v[240:243], v141 offset:256
    v_perm_b32 v234, v14, v154, v4
    v_mfma_f32_16x16x32_bf16 v[28:31], a[108:111], v[60:63], v[28:31]
    ds_read_b128 a[96:99], v106 offset:16
    v_perm_b32 v238, v15, v155, v4
    v_mfma_f32_16x16x32_bf16 v[24:27], a[108:111], v[56:59], v[24:27]
    v_mov_b32_dpp v12, v156 row_ror:8 row_mask:0xf bank_mask:0xf
    v_mov_b32_dpp v13, v157 row_ror:8 row_mask:0xf bank_mask:0xf
    v_mfma_f32_16x16x32_bf16 v[24:27], a[104:107], v[216:219], v[24:27]
    v_perm_b32 v227, v12, v156, v4
    v_perm_b32 v231, v13, v157, v4
    v_mfma_f32_16x16x32_bf16 v[20:23], a[104:107], v[212:215], v[20:23]
    v_mov_b32_dpp v14, v158 row_ror:8 row_mask:0xf bank_mask:0xf
    v_mov_b32_dpp v15, v159 row_ror:8 row_mask:0xf bank_mask:0xf
    v_mfma_f32_16x16x32_bf16 v[20:23], a[108:111], v[52:55], v[20:23]
    ds_read_b128 a[100:103], v106 offset:32
    v_perm_b32 v235, v14, v158, v4
    v_mfma_f32_16x16x32_bf16 v[16:19], a[108:111], v[48:51], v[16:19]
    v_perm_b32 v239, v15, v159, v4
    v_mov_b32_dpp v12, v160 row_ror:8 row_mask:0xf bank_mask:0xf
    v_mfma_f32_16x16x32_bf16 v[16:19], a[104:107], v[208:211], v[16:19]
    s_waitcnt vmcnt(11) lgkmcnt(2)
    v_mov_b32_dpp v13, v161 row_ror:8 row_mask:0xf bank_mask:0xf
    v_perm_b32 v144, v12, v160, v4
    v_mfma_f32_16x16x32_bf16 a[48:51], a[112:115], v[48:51], a[48:51]
    v_lshl_add_u32 v240, v240, 8, v11
    v_lshl_add_u32 v241, v241, 8, v11
    v_mfma_f32_16x16x32_bf16 a[48:51], a[116:119], v[64:67], a[48:51]
    ds_read_b128 a[104:107], v110 offset:16
    v_lshl_add_u32 v242, v242, 8, v11
L_pg3:
    s_cbranch_execz L_pg4
    v_mfma_f32_16x16x32_bf16 a[52:55], a[116:119], v[68:71], a[52:55]
    v_lshl_add_u32 v243, v243, 8, v11
    v_cndmask_b32_e64 v82, 0, v0, s[48:49]
    v_mfma_f32_16x16x32_bf16 a[52:55], a[112:115], v[52:55], a[52:55]
    v_cndmask_b32_e64 v88, 0, v0, s[48:49]
    v_perm_b32 v148, v13, v161, v4
    v_mfma_f32_16x16x32_bf16 a[56:59], a[112:115], v[56:59], a[56:59]
    s_lshl_b64 s[48:49], s[48:49], 2
    v_cndmask_b32_e64 v83, 0, v0, s[48:49]
    v_cndmask_b32_e64 v89, 0, v0, s[48:49]
    v_mfma_f32_16x16x32_bf16 a[56:59], a[116:119], v[72:75], a[56:59]
    ds_read_b128 a[108:111], v110 offset:32
    v_mov_b32_dpp v14, v162 row_ror:8 row_mask:0xf bank_mask:0xf
    v_mfma_f32_16x16x32_bf16 a[60:63], a[116:119], v[76:79], a[60:63]
    v_mov_b32_dpp v15, v163 row_ror:8 row_mask:0xf bank_mask:0xf
    v_perm_b32 v152, v14, v162, v4
    v_mfma_f32_16x16x32_bf16 a[60:63], a[112:115], v[60:63], a[60:63]
    s_waitcnt vmcnt(10)
    v_perm_b32 v156, v15, v163, v4
    v_mov_b32_dpp v12, v164 row_ror:8 row_mask:0xf bank_mask:0xf
    v_mfma_f32_16x16x32_bf16 a[76:79], a[120:123], v[60:63], a[76:79]
    ds_read_b128 v[136:139], v141 offset:320
    v_mov_b32_dpp v13, v165 row_ror:8 row_mask:0xf bank_mask:0xf
    v_mfma_f32_16x16x32_bf16 a[76:79], a[124:127], v[76:79], a[76:79]
    ds_read_b128 a[112:115], v107 offset:32
    v_perm_b32 v145, v12, v164, v4
    v_mfma_f32_16x16x32_bf16 a[72:75], a[124:127], v[72:75], a[72:75]
    v_perm_b32 v149, v13, v165, v4
    v_mov_b32_dpp v14, v166 row_ror:8 row_mask:0xf bank_mask:0xf
    v_mfma_f32_16x16x32_bf16 a[72:75], a[120:123], v[56:59], a[72:75]
    v_mov_b32_dpp v15, v167 row_ror:8 row_mask:0xf bank_mask:0xf
    v_perm_b32 v153, v14, v166, v4
    v_mfma_f32_16x16x32_bf16 a[68:71], a[120:123], v[52:55], a[68:71]
    v_perm_b32 v157, v15, v167, v4
    v_mov_b32_dpp v12, v168 row_ror:8 row_mask:0xf bank_mask:0xf
    v_mfma_f32_16x16x32_bf16 a[68:71], a[124:127], v[68:71], a[68:71]
    ds_read_b128 a[116:119], v107 offset:48
    v_mov_b32_dpp v13, v169 row_ror:8 row_mask:0xf bank_mask:0xf
    v_mfma_f32_16x16x32_bf16 a[64:67], a[124:127], v[64:67], a[64:67]
    v_perm_b32 v146, v12, v168, v4
    v_perm_b32 v150, v13, v169, v4
    v_mfma_f32_16x16x32_bf16 a[64:67], a[120:123], v[48:51], a[64:67]
    s_waitcnt vmcnt(9) lgkmcnt(2)
    v_mov_b32_dpp v14, v170 row_ror:8 row_mask:0xf bank_mask:0xf
    v_mov_b32_dpp v15, v171 row_ror:8 row_mask:0xf bank_mask:0xf
    v_mfma_f32_16x16x32_bf16 a[80:83], a[128:131], v[48:51], a[80:83]
    v_lshl_add_u32 v136, v136, 8, v11
    v_lshl_add_u32 v137, v137, 8, v11
    v_mfma_f32_16x16x32_bf16 a[80:83], a[132:135], v[64:67], a[80:83]
    ds_read_b128 a[120:123], v108 offset:32
    v_lshl_add_u32 v138, v138, 8, v11
    v_mfma_f32_16x16x32_bf16 a[84:87], a[132:135], v[68:71], a[84:87]
    v_lshl_add_u32 v139, v139, 8, v11
    v_perm_b32 v154, v14, v170, v4
    v_mfma_f32_16x16x32_bf16 a[84:87], a[128:131], v[52:55], a[84:87]
    v_perm_b32 v158, v15, v171, v4
    v_mov_b32_dpp v12, v172 row_ror:8 row_mask:0xf bank_mask:0xf
    v_mfma_f32_16x16x32_bf16 a[88:91], a[128:131], v[56:59], a[88:91]
    v_mov_b32_dpp v13, v173 row_ror:8 row_mask:0xf bank_mask:0xf
    v_perm_b32 v147, v12, v172, v4
    v_mfma_f32_16x16x32_bf16 a[88:91], a[132:135], v[72:75], a[88:91]
    ds_read_b128 a[124:127], v108 offset:48
    v_perm_b32 v151, v13, v173, v4
    v_mfma_f32_16x16x32_bf16 a[92:95], a[132:135], v[76:79], a[92:95]
    v_mov_b32_dpp v14, v174 row_ror:8 row_mask:0xf bank_mask:0xf
    v_mov_b32_dpp v15, v175 row_ror:8 row_mask:0xf bank_mask:0xf
    v_mfma_f32_16x16x32_bf16 a[92:95], a[128:131], v[60:63], a[92:95]
    v_perm_b32 v155, v14, v174, v4
    v_perm_b32 v159, v15, v175, v4
    v_mfma_f32_16x16x32_bf16 v[44:47], a[136:139], v[60:63], v[44:47]
    buffer_load_dwordx4 v[208:211], v2, s[32:35], s77 offen offset:0
    v_mfma_f32_16x16x32_bf16 v[44:47], a[140:143], v[76:79], v[44:47]
    s_add_u32 m0, s3, 17408
    ds_read_b128 a[128:131], v109 offset:32
    v_mfma_f32_16x16x32_bf16 v[40:43], a[140:143], v[72:75], v[40:43]
    v_mfma_f32_16x16x32_bf16 v[40:43], a[136:139], v[56:59], v[40:43]
    v_mfma_f32_16x16x32_bf16 v[36:39], a[136:139], v[52:55], v[36:39]
    buffer_load_dwordx4 v[212:215], v2, s[32:35], s77 offen offset:2048
    v_mfma_f32_16x16x32_bf16 v[36:39], a[140:143], v[68:71], v[36:39]
    ds_read_b128 a[132:135], v109 offset:48
    v_mfma_f32_16x16x32_bf16 v[32:35], a[140:143], v[64:67], v[32:35]
    v_mfma_f32_16x16x32_bf16 v[32:35], a[136:139], v[48:51], v[32:35]
    s_waitcnt vmcnt(8)
    v_mfma_f32_16x16x32_bf16 a[0:3], v[64:67], a[144:147], a[0:3]
    buffer_load_dwordx4 v[216:219], v3, s[32:35], s77 offen offset:0
    v_mfma_f32_16x16x32_bf16 a[0:3], v[224:227], a[148:151], a[0:3]
    ds_read_b128 a[136:139], v111 offset:32
    v_mfma_f32_16x16x32_bf16 a[4:7], v[228:231], a[148:151], a[4:7]
    v_mov_b32_dpp v12, v176 row_ror:8 row_mask:0xf bank_mask:0xf
    v_mov_b32_dpp v13, v177 row_ror:8 row_mask:0xf bank_mask:0xf
    v_mfma_f32_16x16x32_bf16 a[4:7], v[68:71], a[144:147], a[4:7]
    v_perm_b32 v160, v12, v176, v4
    v_perm_b32 v164, v13, v177, v4
    v_mfma_f32_16x16x32_bf16 a[8:11], v[72:75], a[144:147], a[8:11]
    buffer_load_dwordx4 v[220:223], v3, s[32:35], s77 offen offset:2048
    v_mfma_f32_16x16x32_bf16 a[8:11], v[232:235], a[148:151], a[8:11]
    ds_read_b128 a[140:143], v111 offset:48
    v_mov_b32_dpp v14, v178 row_ror:8 row_mask:0xf bank_mask:0xf
    v_mfma_f32_16x16x32_bf16 a[12:15], v[236:239], a[148:151], a[12:15]
    v_mov_b32_dpp v15, v179 row_ror:8 row_mask:0xf bank_mask:0xf
    v_perm_b32 v168, v14, v178, v4
    v_mfma_f32_16x16x32_bf16 a[12:15], v[76:79], a[144:147], a[12:15]
    s_waitcnt vmcnt(9)
    v_perm_b32 v172, v15, v179, v4
    v_mov_b32_dpp v12, v180 row_ror:8 row_mask:0xf bank_mask:0xf
    v_mfma_f32_16x16x32_bf16 a[28:31], v[76:79], a[152:155], a[28:31]
    buffer_load_dwordx4 v240, s[28:31], s44 offen offset:0 lds
    v_mfma_f32_16x16x32_bf16 a[28:31], v[236:239], a[156:159], a[28:31]
    ds_read_b128 a[144:147], v104 offset:48
    v_mov_b32_dpp v13, v181 row_ror:8 row_mask:0xf bank_mask:0xf
    v_mfma_f32_16x16x32_bf16 a[24:27], v[232:235], a[156:159], a[24:27]
    v_perm_b32 v161, v12, v180, v4
    v_perm_b32 v165, v13, v181, v4
    v_mfma_f32_16x16x32_bf16 a[24:27], v[72:75], a[152:155], a[24:27]
    v_mov_b32_dpp v14, v182 row_ror:8 row_mask:0xf bank_mask:0xf
    v_mov_b32_dpp v15, v183 row_ror:8 row_mask:0xf bank_mask:0xf
    v_mfma_f32_16x16x32_bf16 a[20:23], v[68:71], a[152:155], a[20:23]
    buffer_load_dwordx4 v241, s[28:31], s45 offen offset:1088 lds
    v_mfma_f32_16x16x32_bf16 a[20:23], v[228:231], a[156:159], a[20:23]
    ds_read_b128 a[148:151], v112 offset:0
    v_perm_b32 v169, v14, v182, v4
    v_mfma_f32_16x16x32_bf16 a[16:19], v[224:227], a[156:159], a[16:19]
    v_perm_b32 v173, v15, v183, v4
    v_mov_b32_dpp v12, v184 row_ror:8 row_mask:0xf bank_mask:0xf
    v_mfma_f32_16x16x32_bf16 a[16:19], v[64:67], a[152:155], a[16:19]
    s_waitcnt vmcnt(10)
    v_mov_b32_dpp v13, v185 row_ror:8 row_mask:0xf bank_mask:0xf
    v_perm_b32 v162, v12, v184, v4
    v_mfma_f32_16x16x32_bf16 a[32:35], a[96:99], v[64:67], a[32:35]
    buffer_load_dwordx4 v242, s[28:31], s46 offen offset:2176 lds
    v_mfma_f32_16x16x32_bf16 a[32:35], a[100:103], v[224:227], a[32:35]
    ds_read_b128 a[152:155], v105 offset:48
    v_perm_b32 v166, v13, v185, v4
    v_mfma_f32_16x16x32_bf16 a[36:39], a[100:103], v[228:231], a[36:39]
    v_mov_b32_dpp v14, v186 row_ror:8 row_mask:0xf bank_mask:0xf
    v_mov_b32_dpp v15, v187 row_ror:8 row_mask:0xf bank_mask:0xf
    v_mfma_f32_16x16x32_bf16 a[36:39], a[96:99], v[68:71], a[36:39]
    v_perm_b32 v170, v14, v186, v4
    v_perm_b32 v174, v15, v187, v4
    v_mfma_f32_16x16x32_bf16 a[40:43], a[96:99], v[72:75], a[40:43]
    buffer_load_dwordx4 v243, s[28:31], 0 offen offset:3264 lds
    v_mfma_f32_16x16x32_bf16 a[40:43], a[100:103], v[232:235], a[40:43]
    s_add_u32 m0, s3, 34816
    ds_read_b128 a[156:159], v113 offset:0
    v_lshrrev_b32 v241, 4, v1
    v_mfma_f32_16x16x32_bf16 a[44:47], a[100:103], v[236:239], a[44:47]
    v_lshlrev_b32 v241, 15, v241
    v_and_b32 v242, 0xf0, v5
    v_mfma_f32_16x16x32_bf16 a[44:47], a[96:99], v[76:79], a[44:47]
    s_waitcnt vmcnt(11)
    v_add_u32 v241, v241, v242
    v_mov_b32_dpp v12, v188 row_ror:8 row_mask:0xf bank_mask:0xf
    v_mfma_f32_16x16x32_bf16 v[28:31], a[104:107], v[76:79], v[28:31]
    buffer_load_dwordx4 v136, s[28:31], s44 offen offset:0 lds
    v_mfma_f32_16x16x32_bf16 v[28:31], a[108:111], v[236:239], v[28:31]
    ds_read_b128 a[96:99], v106 offset:48
    v_mov_b32_dpp v13, v189 row_ror:8 row_mask:0xf bank_mask:0xf
    v_mfma_f32_16x16x32_bf16 v[24:27], a[108:111], v[232:235], v[24:27]
    v_perm_b32 v163, v12, v188, v4
    v_perm_b32 v167, v13, v189, v4
    v_mfma_f32_16x16x32_bf16 v[24:27], a[104:107], v[72:75], v[24:27]
    v_mov_b32_dpp v14, v190 row_ror:8 row_mask:0xf bank_mask:0xf
    v_mov_b32_dpp v15, v191 row_ror:8 row_mask:0xf bank_mask:0xf
    v_mfma_f32_16x16x32_bf16 v[20:23], a[104:107], v[68:71], v[20:23]
    buffer_load_dwordx4 v137, s[28:31], s45 offen offset:1088 lds
    v_mfma_f32_16x16x32_bf16 v[20:23], a[108:111], v[228:231], v[20:23]
    ds_read_b128 a[100:103], v114 offset:0
    v_perm_b32 v171, v14, v190, v4
    v_mfma_f32_16x16x32_bf16 v[16:19], a[108:111], v[224:227], v[16:19]
    v_perm_b32 v175, v15, v191, v4
    v_mov_b32_dpp v12, v192 row_ror:8 row_mask:0xf bank_mask:0xf
    v_mfma_f32_16x16x32_bf16 v[16:19], a[104:107], v[64:67], v[16:19]
    s_waitcnt vmcnt(12) lgkmcnt(12)
    v_mov_b32_dpp v13, v193 row_ror:8 row_mask:0xf bank_mask:0xf
    v_perm_b32 v176, v12, v192, v4
    v_mfma_f32_16x16x32_bf16 a[48:51], a[112:115], v[224:227], a[48:51]
    buffer_load_dwordx4 v138, s[28:31], s46 offen offset:2176 lds
    v_mfma_f32_16x16x32_bf16 a[48:51], a[116:119], v[144:147], a[48:51]
    ds_read_b128 a[104:107], v110 offset:48
    v_perm_b32 v180, v13, v193, v4
    v_mfma_f32_16x16x32_bf16 a[52:55], a[116:119], v[148:151], a[52:55]
    v_mov_b32_dpp v14, v194 row_ror:8 row_mask:0xf bank_mask:0xf
    v_mov_b32_dpp v15, v195 row_ror:8 row_mask:0xf bank_mask:0xf
    v_mfma_f32_16x16x32_bf16 a[52:55], a[112:115], v[228:231], a[52:55]
    ds_read_b128 v[96:99], v117 offset:48
    v_perm_b32 v184, v14, v194, v4
    v_mfma_f32_16x16x32_bf16 a[56:59], a[112:115], v[232:235], a[56:59]
    buffer_load_dwordx4 v139, s[28:31], 0 offen offset:3264 lds
    v_mfma_f32_16x16x32_bf16 a[56:59], a[116:119], v[152:155], a[56:59]
    ds_read_b128 a[108:111], v118 offset:0
    v_perm_b32 v188, v15, v195, v4
    v_mfma_f32_16x16x32_bf16 a[60:63], a[116:119], v[156:159], a[60:63]
    s_lshl_b32 s92, s89, 8
    v_mov_b32_dpp v12, v196 row_ror:8 row_mask:0xf bank_mask:0xf
    v_mov_b32_dpp v13, v197 row_ror:8 row_mask:0xf bank_mask:0xf
    v_mfma_f32_16x16x32_bf16 a[60:63], a[112:115], v[236:239], a[60:63]
    s_waitcnt vmcnt(13) lgkmcnt(13)
    v_perm_b32 v177, v12, v196, v4
    v_perm_b32 v181, v13, v197, v4
    v_mfma_f32_16x16x32_bf16 a[76:79], a[120:123], v[236:239], a[76:79]
    buffer_load_dwordx4 v[48:51], v2, s[32:35], s78 offen offset:0
    v_mfma_f32_16x16x32_bf16 a[76:79], a[124:127], v[156:159], a[76:79]
    s_xor_b32 m0, s92, 65280
    ds_read_b128 a[112:115], v115 offset:0
    v_mov_b32_dpp v14, v198 row_ror:8 row_mask:0xf bank_mask:0xf
    v_mfma_f32_16x16x32_bf16 a[72:75], a[124:127], v[152:155], a[72:75]
    v_mov_b32_dpp v15, v199 row_ror:8 row_mask:0xf bank_mask:0xf
    v_perm_b32 v185, v14, v198, v4
    v_mfma_f32_16x16x32_bf16 a[72:75], a[120:123], v[232:235], a[72:75]
    v_perm_b32 v189, v15, v199, v4
    v_mov_b32_dpp v12, v200 row_ror:8 row_mask:0xf bank_mask:0xf
    v_mfma_f32_16x16x32_bf16 a[68:71], a[120:123], v[228:231], a[68:71]
    buffer_load_dwordx4 v[52:55], v2, s[32:35], s78 offen offset:2048
    v_mfma_f32_16x16x32_bf16 a[68:71], a[124:127], v[148:151], a[68:71]
    ds_read_b128 a[116:119], v131 offset:0
    v_mov_b32_dpp v13, v201 row_ror:8 row_mask:0xf bank_mask:0xf
    v_mfma_f32_16x16x32_bf16 a[64:67], a[124:127], v[144:147], a[64:67]
    v_perm_b32 v178, v12, v200, v4
    v_perm_b32 v182, v13, v201, v4
    v_mfma_f32_16x16x32_bf16 a[64:67], a[120:123], v[224:227], a[64:67]
    s_waitcnt vmcnt(14) lgkmcnt(13)
    ds_read_b128 v[100:103], v124 offset:48
    v_mov_b32_dpp v14, v202 row_ror:8 row_mask:0xf bank_mask:0xf
    v_mfma_f32_16x16x32_bf16 a[80:83], a[128:131], v[224:227], a[80:83]
    buffer_load_dwordx4 v[56:59], v3, s[32:35], s78 offen offset:0
    v_mfma_f32_16x16x32_bf16 a[80:83], a[132:135], v[144:147], a[80:83]
    ds_read_b128 a[120:123], v116 offset:0
    v_mov_b32_dpp v15, v203 row_ror:8 row_mask:0xf bank_mask:0xf
    v_mfma_f32_16x16x32_bf16 a[84:87], a[132:135], v[148:151], a[84:87]
    v_perm_b32 v186, v14, v202, v4
    v_perm_b32 v190, v15, v203, v4
    v_mfma_f32_16x16x32_bf16 a[84:87], a[128:131], v[228:231], a[84:87]
    v_mov_b32_dpp v12, v204 row_ror:8 row_mask:0xf bank_mask:0xf
    v_mov_b32_dpp v13, v205 row_ror:8 row_mask:0xf bank_mask:0xf
    v_mfma_f32_16x16x32_bf16 a[88:91], a[128:131], v[232:235], a[88:91]
    buffer_load_dwordx4 v[60:63], v3, s[32:35], s78 offen offset:2048
    v_mfma_f32_16x16x32_bf16 a[88:91], a[132:135], v[152:155], a[88:91]
    ds_read_b128 a[124:127], v132 offset:0
    v_perm_b32 v179, v12, v204, v4
    v_mfma_f32_16x16x32_bf16 a[92:95], a[132:135], v[156:159], a[92:95]
    v_perm_b32 v183, v13, v205, v4
    v_mov_b32_dpp v14, v206 row_ror:8 row_mask:0xf bank_mask:0xf
    v_mfma_f32_16x16x32_bf16 a[92:95], a[128:131], v[236:239], a[92:95]
    s_waitcnt vmcnt(15) lgkmcnt(14)
    v_mov_b32_dpp v15, v207 row_ror:8 row_mask:0xf bank_mask:0xf
    v_perm_b32 v187, v14, v206, v4
    v_mfma_f32_16x16x32_bf16 v[44:47], a[136:139], v[236:239], v[44:47]
    buffer_load_dwordx4 v[64:67], v2, s[32:35], s79 offen offset:0
    v_mfma_f32_16x16x32_bf16 v[44:47], a[140:143], v[156:159], v[44:47]
    ds_read_b128 a[128:131], v117 offset:0
    v_perm_b32 v191, v15, v207, v4
    v_mfma_f32_16x16x32_bf16 v[40:43], a[140:143], v[152:155], v[40:43]
    v_mov_b32_dpp v12, v208 row_ror:8 row_mask:0xf bank_mask:0xf
    v_mov_b32_dpp v13, v209 row_ror:8 row_mask:0xf bank_mask:0xf
    v_mfma_f32_16x16x32_bf16 v[40:43], a[136:139], v[232:235], v[40:43]
    ds_read_b128 v[104:107], v124 offset:32
    v_perm_b32 v192, v12, v208, v4
    v_mfma_f32_16x16x32_bf16 v[36:39], a[136:139], v[228:231], v[36:39]
    buffer_load_dwordx4 v[68:71], v2, s[32:35], s79 offen offset:2048
    v_mfma_f32_16x16x32_bf16 v[36:39], a[140:143], v[148:151], v[36:39]
    ds_read_b128 a[132:135], v133 offset:0
    v_perm_b32 v196, v13, v209, v4
    v_mfma_f32_16x16x32_bf16 v[32:35], a[140:143], v[144:147], v[32:35]
    v_mov_b32_dpp v14, v210 row_ror:8 row_mask:0xf bank_mask:0xf
    v_mov_b32_dpp v15, v211 row_ror:8 row_mask:0xf bank_mask:0xf
    v_mfma_f32_16x16x32_bf16 v[32:35], a[136:139], v[224:227], v[32:35]
    s_waitcnt vmcnt(10) lgkmcnt(14)
    v_perm_b32 v200, v14, v210, v4
    v_perm_b32 v204, v15, v211, v4
    v_mfma_f32_16x16x32_bf16 a[0:3], v[144:147], a[144:147], a[0:3]
    buffer_load_dwordx4 v[72:75], v3, s[32:35], s79 offen offset:0
    v_mfma_f32_16x16x32_bf16 a[0:3], v[160:163], a[148:151], a[0:3]
    ds_read_b128 a[136:139], v119 offset:0
    v_mov_b32_dpp v12, v212 row_ror:8 row_mask:0xf bank_mask:0xf
    v_mfma_f32_16x16x32_bf16 a[4:7], v[164:167], a[148:151], a[4:7]
    v_mov_b32_dpp v13, v213 row_ror:8 row_mask:0xf bank_mask:0xf
    v_perm_b32 v193, v12, v212, v4
    v_mfma_f32_16x16x32_bf16 a[4:7], v[148:151], a[144:147], a[4:7]
    v_perm_b32 v197, v13, v213, v4
    v_mov_b32_dpp v14, v214 row_ror:8 row_mask:0xf bank_mask:0xf
    v_mfma_f32_16x16x32_bf16 a[8:11], v[152:155], a[144:147], a[8:11]
    buffer_load_dwordx4 v[76:79], v3, s[32:35], s79 offen offset:2048
    v_mfma_f32_16x16x32_bf16 a[8:11], v[168:171], a[148:151], a[8:11]
    ds_read_b128 a[140:143], v135 offset:0
    v_mov_b32_dpp v15, v215 row_ror:8 row_mask:0xf bank_mask:0xf
    v_mfma_f32_16x16x32_bf16 a[12:15], v[172:175], a[148:151], a[12:15]
    ds_read_b128 a[224:227], v143 offset:17408
    v_perm_b32 v201, v14, v214, v4
    v_mfma_f32_16x16x32_bf16 a[12:15], v[156:159], a[144:147], a[12:15]
    s_waitcnt lgkmcnt(14)
    ds_read_b128 a[228:231], v143 offset:17472
    v_perm_b32 v205, v15, v215, v4
    v_mfma_f32_16x16x32_bf16 a[28:31], v[156:159], a[152:155], a[28:31]
    buffer_load_dwordx4 v[224:227], v2, s[32:35], s80 offen offset:0
    v_mfma_f32_16x16x32_bf16 a[28:31], v[172:175], a[156:159], a[28:31]
    ds_read_b128 a[144:147], v128 offset:0
    v_mov_b32_dpp v12, v216 row_ror:8 row_mask:0xf bank_mask:0xf
    v_mfma_f32_16x16x32_bf16 a[24:27], v[168:171], a[156:159], a[24:27]
    ds_read_b128 a[232:235], v143 offset:17536
    v_mov_b32_dpp v13, v217 row_ror:8 row_mask:0xf bank_mask:0xf
    v_mfma_f32_16x16x32_bf16 a[24:27], v[152:155], a[152:155], a[24:27]
    ds_read_b128 a[236:239], v143 offset:17600
    v_perm_b32 v194, v12, v216, v4
    v_mfma_f32_16x16x32_bf16 a[20:23], v[148:151], a[152:155], a[20:23]
    buffer_load_dwordx4 v[228:231], v2, s[32:35], s80 offen offset:2048
    v_mfma_f32_16x16x32_bf16 a[20:23], v[164:167], a[156:159], a[20:23]
    ds_read_b128 a[148:151], v112 offset:16
    v_perm_b32 v198, v13, v217, v4
    v_mfma_f32_16x16x32_bf16 a[16:19], v[160:163], a[156:159], a[16:19]
    v_mov_b32_dpp v14, v218 row_ror:8 row_mask:0xf bank_mask:0xf
    v_mov_b32_dpp v15, v219 row_ror:8 row_mask:0xf bank_mask:0xf
    v_mfma_f32_16x16x32_bf16 a[16:19], v[144:147], a[152:155], a[16:19]
    s_waitcnt vmcnt(10)
    ds_read_b128 v[108:111], v124 offset:16
    v_perm_b32 v202, v14, v218, v4
    v_mfma_f32_16x16x32_bf16 a[32:35], a[96:99], v[144:147], a[32:35]
    buffer_load_dwordx4 v[232:235], v3, s[32:35], s80 offen offset:0
    v_mfma_f32_16x16x32_bf16 a[32:35], a[100:103], v[160:163], a[32:35]
    ds_read_b128 a[152:155], v129 offset:0
    v_perm_b32 v206, v15, v219, v4
    v_mfma_f32_16x16x32_bf16 a[36:39], a[100:103], v[164:167], a[36:39]
    v_mov_b32_dpp v12, v220 row_ror:8 row_mask:0xf bank_mask:0xf
    v_mov_b32_dpp v13, v221 row_ror:8 row_mask:0xf bank_mask:0xf
    v_mfma_f32_16x16x32_bf16 a[36:39], a[96:99], v[148:151], a[36:39]
    v_perm_b32 v195, v12, v220, v4
    v_perm_b32 v199, v13, v221, v4
    v_mfma_f32_16x16x32_bf16 a[40:43], a[96:99], v[152:155], a[40:43]
    buffer_load_dwordx4 v[236:239], v3, s[32:35], s80 offen offset:2048
    v_mfma_f32_16x16x32_bf16 a[40:43], a[100:103], v[168:171], a[40:43]
    ds_read_b128 a[156:159], v113 offset:16
    v_mov_b32_dpp v14, v222 row_ror:8 row_mask:0xf bank_mask:0xf
    v_mfma_f32_16x16x32_bf16 a[44:47], a[100:103], v[172:175], a[44:47]
    ds_read_b128 a[240:243], v143 offset:34816
    v_mov_b32_dpp v15, v223 row_ror:8 row_mask:0xf bank_mask:0xf
    v_mfma_f32_16x16x32_bf16 a[44:47], a[96:99], v[156:159], a[44:47]
    s_waitcnt vmcnt(10) lgkmcnt(14)
    ds_read_b128 a[244:247], v143 offset:34880
    v_perm_b32 v203, v14, v222, v4
    v_mfma_f32_16x16x32_bf16 v[28:31], a[104:107], v[156:159], v[28:31]
    ds_read_b128 a[248:251], v143 offset:34944
    v_perm_b32 v207, v15, v223, v4
    v_mfma_f32_16x16x32_bf16 v[28:31], a[108:111], v[172:175], v[28:31]
    ds_read_b128 a[96:99], v130 offset:0
    v_mov_b32_dpp v12, v48 row_ror:8 row_mask:0xf bank_mask:0xf
    v_mfma_f32_16x16x32_bf16 v[24:27], a[108:111], v[168:171], v[24:27]
    ds_read_b128 a[252:255], v143 offset:35008
    v_mov_b32_dpp v13, v49 row_ror:8 row_mask:0xf bank_mask:0xf
    v_mfma_f32_16x16x32_bf16 v[24:27], a[104:107], v[152:155], v[24:27]
    ds_read_b128 v[136:139], v127 offset:48
    v_perm_b32 v208, v12, v48, v4
    v_mfma_f32_16x16x32_bf16 v[20:23], a[104:107], v[148:151], v[20:23]
    v_perm_b32 v212, v13, v49, v4
    v_mov_b32_dpp v14, v50 row_ror:8 row_mask:0xf bank_mask:0xf
    v_mfma_f32_16x16x32_bf16 v[20:23], a[108:111], v[164:167], v[20:23]
    ds_read_b128 a[100:103], v114 offset:16
    v_mov_b32_dpp v15, v51 row_ror:8 row_mask:0xf bank_mask:0xf
    v_mfma_f32_16x16x32_bf16 v[16:19], a[108:111], v[160:163], v[16:19]
    v_perm_b32 v216, v14, v50, v4
    v_perm_b32 v220, v15, v51, v4
    v_mfma_f32_16x16x32_bf16 v[16:19], a[104:107], v[144:147], v[16:19]
    s_waitcnt vmcnt(9)
    v_mov_b32_dpp v12, v52 row_ror:8 row_mask:0xf bank_mask:0xf
    v_mov_b32_dpp v13, v53 row_ror:8 row_mask:0xf bank_mask:0xf
    v_mfma_f32_16x16x32_bf16 a[48:51], a[112:115], v[160:163], a[48:51]
    buffer_load_dwordx4 v[144:147], v2, s[32:35], s81 offen offset:0
    v_mfma_f32_16x16x32_bf16 a[48:51], a[116:119], v[176:179], a[48:51]
    ds_read_b128 a[104:107], v134 offset:0
    v_perm_b32 v209, v12, v52, v4
    v_mfma_f32_16x16x32_bf16 a[52:55], a[116:119], v[180:183], a[52:55]
    v_perm_b32 v213, v13, v53, v4
    v_mov_b32_dpp v14, v54 row_ror:8 row_mask:0xf bank_mask:0xf
    v_mfma_f32_16x16x32_bf16 a[52:55], a[112:115], v[164:167], a[52:55]
    v_mov_b32_dpp v15, v55 row_ror:8 row_mask:0xf bank_mask:0xf
    v_perm_b32 v217, v14, v54, v4
    v_mfma_f32_16x16x32_bf16 a[56:59], a[112:115], v[168:171], a[56:59]
    buffer_load_dwordx4 v[148:151], v2, s[32:35], s81 offen offset:2048
    v_mfma_f32_16x16x32_bf16 a[56:59], a[116:119], v[184:187], a[56:59]
    ds_read_b128 a[108:111], v118 offset:16
    v_perm_b32 v221, v15, v55, v4
    v_mfma_f32_16x16x32_bf16 a[60:63], a[116:119], v[188:191], a[60:63]
    v_mov_b32_dpp v12, v56 row_ror:8 row_mask:0xf bank_mask:0xf
    v_mov_b32_dpp v13, v57 row_ror:8 row_mask:0xf bank_mask:0xf
    v_mfma_f32_16x16x32_bf16 a[60:63], a[112:115], v[172:175], a[60:63]
    s_waitcnt vmcnt(10)
    ds_read_b128 v[140:143], v127 offset:32
    v_perm_b32 v210, v12, v56, v4
    v_mfma_f32_16x16x32_bf16 a[76:79], a[120:123], v[172:175], a[76:79]
    buffer_load_dwordx4 v[152:155], v3, s[32:35], s81 offen offset:0
    v_mfma_f32_16x16x32_bf16 a[76:79], a[124:127], v[188:191], a[76:79]
    ds_read_b128 a[112:115], v115 offset:16
    v_perm_b32 v214, v13, v57, v4
    v_mfma_f32_16x16x32_bf16 a[72:75], a[124:127], v[184:187], a[72:75]
    v_mov_b32_dpp v14, v58 row_ror:8 row_mask:0xf bank_mask:0xf
    v_mov_b32_dpp v15, v59 row_ror:8 row_mask:0xf bank_mask:0xf
    v_mfma_f32_16x16x32_bf16 a[72:75], a[120:123], v[168:171], a[72:75]
    v_perm_b32 v218, v14, v58, v4
    v_perm_b32 v222, v15, v59, v4
    v_mfma_f32_16x16x32_bf16 a[68:71], a[120:123], v[164:167], a[68:71]
    buffer_load_dwordx4 v[156:159], v3, s[32:35], s81 offen offset:2048
    v_mfma_f32_16x16x32_bf16 a[68:71], a[124:127], v[180:183], a[68:71]
    ds_read_b128 a[116:119], v115 offset:32
    v_mov_b32_dpp v12, v60 row_ror:8 row_mask:0xf bank_mask:0xf
    v_mfma_f32_16x16x32_bf16 a[64:67], a[124:127], v[176:179], a[64:67]
    v_mov_b32_dpp v13, v61 row_ror:8 row_mask:0xf bank_mask:0xf
    v_perm_b32 v211, v12, v60, v4
    v_mfma_f32_16x16x32_bf16 a[64:67], a[120:123], v[160:163], a[64:67]
    s_waitcnt vmcnt(11) lgkmcnt(14)
    v_perm_b32 v215, v13, v61, v4
    v_mov_b32_dpp v14, v62 row_ror:8 row_mask:0xf bank_mask:0xf
    v_mfma_f32_16x16x32_bf16 a[80:83], a[128:131], v[160:163], a[80:83]
    v_mov_b32_dpp v15, v63 row_ror:8 row_mask:0xf bank_mask:0xf
    v_perm_b32 v219, v14, v62, v4
    v_mfma_f32_16x16x32_bf16 a[80:83], a[132:135], v[176:179], a[80:83]
    ds_read_b128 a[120:123], v116 offset:16
    v_perm_b32 v223, v15, v63, v4
    v_mfma_f32_16x16x32_bf16 a[84:87], a[132:135], v[180:183], a[84:87]
    s_waitcnt lgkmcnt(8)
    s_barrier
    v_mov_b32_dpp v12, v64 row_ror:8 row_mask:0xf bank_mask:0xf
    v_mfma_f32_16x16x32_bf16 a[84:87], a[128:131], v[164:167], a[84:87]
    ds_read_b64 v[80:81], v255 offset:0
    v_mov_b32_dpp v13, v65 row_ror:8 row_mask:0xf bank_mask:0xf
    v_mfma_f32_16x16x32_bf16 a[88:91], a[128:131], v[168:171], a[88:91]
    ds_read_b64 v[84:85], v255 offset:0
    v_perm_b32 v48, v12, v64, v4
    v_mfma_f32_16x16x32_bf16 a[88:91], a[132:135], v[184:187], a[88:91]
    ds_read_b128 a[124:127], v116 offset:32
    v_perm_b32 v52, v13, v65, v4
    v_mfma_f32_16x16x32_bf16 a[92:95], a[132:135], v[188:191], a[92:95]
    ds_read_b64 v[86:87], v255 offset:3232
    v_mov_b32_dpp v14, v66 row_ror:8 row_mask:0xf bank_mask:0xf
    v_mfma_f32_16x16x32_bf16 a[92:95], a[128:131], v[172:175], a[92:95]
    s_waitcnt vmcnt(9)
    ds_read_b64 v[90:91], v255 offset:3232
    v_mov_b32_dpp v15, v67 row_ror:8 row_mask:0xf bank_mask:0xf
    v_mfma_f32_16x16x32_bf16 v[44:47], a[136:139], v[172:175], v[44:47]
    v_perm_b32 v56, v14, v66, v4
    v_perm_b32 v60, v15, v67, v4
    v_mfma_f32_16x16x32_bf16 v[44:47], a[140:143], v[188:191], v[44:47]
    ds_read_b128 a[128:131], v117 offset:16
    v_mov_b32_dpp v12, v68 row_ror:8 row_mask:0xf bank_mask:0xf
    v_mfma_f32_16x16x32_bf16 v[40:43], a[140:143], v[184:187], v[40:43]
    v_mov_b32_dpp v13, v69 row_ror:8 row_mask:0xf bank_mask:0xf
    v_perm_b32 v49, v12, v68, v4
    v_mfma_f32_16x16x32_bf16 v[40:43], a[136:139], v[168:171], v[40:43]
    ds_read_b128 v[128:131], v127 offset:16
    v_perm_b32 v53, v13, v69, v4
    v_mfma_f32_16x16x32_bf16 v[36:39], a[136:139], v[164:167], v[36:39]
    v_mov_b32_dpp v14, v70 row_ror:8 row_mask:0xf bank_mask:0xf
    v_mov_b32_dpp v15, v71 row_ror:8 row_mask:0xf bank_mask:0xf
    v_mfma_f32_16x16x32_bf16 v[36:39], a[140:143], v[180:183], v[36:39]
    ds_read_b128 a[132:135], v117 offset:32
    v_perm_b32 v57, v14, v70, v4
    v_mfma_f32_16x16x32_bf16 v[32:35], a[140:143], v[176:179], v[32:35]
    v_perm_b32 v61, v15, v71, v4
    v_mov_b32_dpp v12, v72 row_ror:8 row_mask:0xf bank_mask:0xf
    v_mfma_f32_16x16x32_bf16 v[32:35], a[136:139], v[160:163], v[32:35]
    s_waitcnt vmcnt(8)
    v_mov_b32_dpp v13, v73 row_ror:8 row_mask:0xf bank_mask:0xf
    v_perm_b32 v50, v12, v72, v4
    v_mfma_f32_16x16x32_bf16 a[0:3], v[176:179], a[144:147], a[0:3]
    buffer_load_dwordx4 v[160:163], v2, s[32:35], s82 offen offset:0
    v_mfma_f32_16x16x32_bf16 a[0:3], v[192:195], a[148:151], a[0:3]
    ds_read_b128 a[136:139], v119 offset:16
    v_perm_b32 v54, v13, v73, v4
    v_mfma_f32_16x16x32_bf16 a[4:7], v[196:199], a[148:151], a[4:7]
    v_mov_b32_dpp v14, v74 row_ror:8 row_mask:0xf bank_mask:0xf
    v_mov_b32_dpp v15, v75 row_ror:8 row_mask:0xf bank_mask:0xf
    v_mfma_f32_16x16x32_bf16 a[4:7], v[180:183], a[144:147], a[4:7]
    v_perm_b32 v58, v14, v74, v4
    v_perm_b32 v62, v15, v75, v4
    v_mfma_f32_16x16x32_bf16 a[8:11], v[184:187], a[144:147], a[8:11]
    buffer_load_dwordx4 v[164:167], v2, s[32:35], s82 offen offset:2048
    v_mfma_f32_16x16x32_bf16 a[8:11], v[200:203], a[148:151], a[8:11]
    ds_read_b128 a[140:143], v119 offset:32
    v_mov_b32_dpp v12, v76 row_ror:8 row_mask:0xf bank_mask:0xf
    v_mfma_f32_16x16x32_bf16 a[12:15], v[204:207], a[148:151], a[12:15]
    v_mov_b32_dpp v13, v77 row_ror:8 row_mask:0xf bank_mask:0xf
    v_perm_b32 v51, v12, v76, v4
    v_mfma_f32_16x16x32_bf16 a[12:15], v[188:191], a[144:147], a[12:15]
    s_waitcnt vmcnt(9)
    ds_read_b128 v[132:135], v127 offset:0
    v_perm_b32 v55, v13, v77, v4
    v_mfma_f32_16x16x32_bf16 a[28:31], v[188:191], a[152:155], a[28:31]
    buffer_load_dwordx4 v[168:171], v3, s[32:35], s82 offen offset:0
    v_mfma_f32_16x16x32_bf16 a[28:31], v[204:207], a[156:159], a[28:31]
    ds_read_b128 a[144:147], v112 offset:32
    v_mov_b32_dpp v14, v78 row_ror:8 row_mask:0xf bank_mask:0xf
    v_mfma_f32_16x16x32_bf16 a[24:27], v[200:203], a[156:159], a[24:27]
    v_mov_b32_dpp v15, v79 row_ror:8 row_mask:0xf bank_mask:0xf
    v_perm_b32 v59, v14, v78, v4
    v_mfma_f32_16x16x32_bf16 a[24:27], v[184:187], a[152:155], a[24:27]
    v_perm_b32 v63, v15, v79, v4
    v_mov_b32_dpp v12, v224 row_ror:8 row_mask:0xf bank_mask:0xf
    v_mfma_f32_16x16x32_bf16 a[20:23], v[180:183], a[152:155], a[20:23]
    buffer_load_dwordx4 v[172:175], v3, s[32:35], s82 offen offset:2048
    v_mfma_f32_16x16x32_bf16 a[20:23], v[196:199], a[156:159], a[20:23]
    ds_read_b128 a[148:151], v112 offset:48
    v_mov_b32_dpp v13, v225 row_ror:8 row_mask:0xf bank_mask:0xf
    v_mfma_f32_16x16x32_bf16 a[16:19], v[192:195], a[156:159], a[16:19]
    v_perm_b32 v64, v12, v224, v4
    v_perm_b32 v68, v13, v225, v4
    v_mfma_f32_16x16x32_bf16 a[16:19], v[176:179], a[152:155], a[16:19]
    s_waitcnt vmcnt(9) lgkmcnt(14)
    v_mov_b32_dpp v14, v226 row_ror:8 row_mask:0xf bank_mask:0xf
    v_mov_b32_dpp v15, v227 row_ror:8 row_mask:0xf bank_mask:0xf
    v_mfma_f32_16x16x32_bf16 a[32:35], a[96:99], v[176:179], a[32:35]
    v_perm_b32 v72, v14, v226, v4
    v_perm_b32 v76, v15, v227, v4
    v_mfma_f32_16x16x32_bf16 a[32:35], a[100:103], v[192:195], a[32:35]
    ds_read_b128 a[152:155], v113 offset:32
    v_mov_b32_dpp v12, v228 row_ror:8 row_mask:0xf bank_mask:0xf
    v_mfma_f32_16x16x32_bf16 a[36:39], a[100:103], v[196:199], a[36:39]
    v_mov_b32_dpp v13, v229 row_ror:8 row_mask:0xf bank_mask:0xf
    v_perm_b32 v65, v12, v228, v4
    v_mfma_f32_16x16x32_bf16 a[36:39], a[96:99], v[180:183], a[36:39]
    v_perm_b32 v69, v13, v229, v4
    v_mov_b32_dpp v14, v230 row_ror:8 row_mask:0xf bank_mask:0xf
    v_mfma_f32_16x16x32_bf16 a[40:43], a[96:99], v[184:187], a[40:43]
    v_mov_b32_dpp v15, v231 row_ror:8 row_mask:0xf bank_mask:0xf
    v_perm_b32 v73, v14, v230, v4
    v_mfma_f32_16x16x32_bf16 a[40:43], a[100:103], v[200:203], a[40:43]
    ds_read_b128 a[156:159], v113 offset:48
    v_perm_b32 v77, v15, v231, v4
    v_mfma_f32_16x16x32_bf16 a[44:47], a[100:103], v[204:207], a[44:47]
    v_mov_b32_dpp v12, v232 row_ror:8 row_mask:0xf bank_mask:0xf
L_pg4:
    s_cbranch_execz L_pg5
    v_mov_b32_dpp v13, v233 row_ror:8 row_mask:0xf bank_mask:0xf
    v_mfma_f32_16x16x32_bf16 a[44:47], a[96:99], v[188:191], a[44:47]
    s_waitcnt vmcnt(7)
    v_perm_b32 v66, v12, v232, v4
    v_perm_b32 v70, v13, v233, v4
    v_mfma_f32_16x16x32_bf16 v[28:31], a[104:107], v[188:191], v[28:31]
    v_mov_b32_dpp v14, v234 row_ror:8 row_mask:0xf bank_mask:0xf
    v_mov_b32_dpp v15, v235 row_ror:8 row_mask:0xf bank_mask:0xf
    v_mfma_f32_16x16x32_bf16 v[28:31], a[108:111], v[204:207], v[28:31]
    ds_read_b128 a[96:99], v114 offset:32
    v_perm_b32 v74, v14, v234, v4
    v_mfma_f32_16x16x32_bf16 v[24:27], a[108:111], v[200:203], v[24:27]
    v_perm_b32 v78, v15, v235, v4
    v_mov_b32_dpp v12, v236 row_ror:8 row_mask:0xf bank_mask:0xf
    v_mfma_f32_16x16x32_bf16 v[24:27], a[104:107], v[184:187], v[24:27]
    v_mov_b32_dpp v13, v237 row_ror:8 row_mask:0xf bank_mask:0xf
    v_perm_b32 v67, v12, v236, v4
    v_mfma_f32_16x16x32_bf16 v[20:23], a[104:107], v[180:183], v[20:23]
    v_perm_b32 v71, v13, v237, v4
    v_mov_b32_dpp v14, v238 row_ror:8 row_mask:0xf bank_mask:0xf
    v_mfma_f32_16x16x32_bf16 v[20:23], a[108:111], v[196:199], v[20:23]
    ds_read_b128 a[100:103], v114 offset:48
    v_mov_b32_dpp v15, v239 row_ror:8 row_mask:0xf bank_mask:0xf
    v_mfma_f32_16x16x32_bf16 v[16:19], a[108:111], v[192:195], v[16:19]
    v_perm_b32 v75, v14, v238, v4
    v_perm_b32 v79, v15, v239, v4
    v_mfma_f32_16x16x32_bf16 v[16:19], a[104:107], v[176:179], v[16:19]
    s_waitcnt vmcnt(6)
    v_mov_b32_dpp v12, v144 row_ror:8 row_mask:0xf bank_mask:0xf
    v_mov_b32_dpp v13, v145 row_ror:8 row_mask:0xf bank_mask:0xf
    v_mfma_f32_16x16x32_bf16 a[48:51], a[112:115], v[192:195], a[48:51]
    buffer_load_dwordx4 v[176:179], v2, s[32:35], s83 offen offset:0
    v_mfma_f32_16x16x32_bf16 a[48:51], a[116:119], v[208:211], a[48:51]
    ds_read_b128 a[104:107], v118 offset:32
    v_perm_b32 v224, v12, v144, v4
    v_mfma_f32_16x16x32_bf16 a[52:55], a[116:119], v[212:215], a[52:55]
    v_perm_b32 v228, v13, v145, v4
    v_mov_b32_dpp v14, v146 row_ror:8 row_mask:0xf bank_mask:0xf
    v_mfma_f32_16x16x32_bf16 a[52:55], a[112:115], v[196:199], a[52:55]
    v_mov_b32_dpp v15, v147 row_ror:8 row_mask:0xf bank_mask:0xf
    v_perm_b32 v232, v14, v146, v4
    v_mfma_f32_16x16x32_bf16 a[56:59], a[112:115], v[200:203], a[56:59]
    buffer_load_dwordx4 v[180:183], v2, s[32:35], s83 offen offset:2048
    v_mfma_f32_16x16x32_bf16 a[56:59], a[116:119], v[216:219], a[56:59]
    ds_read_b128 a[108:111], v118 offset:48
    v_perm_b32 v236, v15, v147, v4
    v_mfma_f32_16x16x32_bf16 a[60:63], a[116:119], v[220:223], a[60:63]
    v_mov_b32_dpp v12, v148 row_ror:8 row_mask:0xf bank_mask:0xf
    v_mov_b32_dpp v13, v149 row_ror:8 row_mask:0xf bank_mask:0xf
    v_mfma_f32_16x16x32_bf16 a[60:63], a[112:115], v[204:207], a[60:63]
    s_waitcnt vmcnt(7) lgkmcnt(14)
    v_perm_b32 v225, v12, v148, v4
    v_perm_b32 v229, v13, v149, v4
    v_mfma_f32_16x16x32_bf16 a[76:79], a[120:123], v[204:207], a[76:79]
    buffer_load_dwordx4 v[184:187], v3, s[32:35], s83 offen offset:0
    v_mfma_f32_16x16x32_bf16 a[76:79], a[124:127], v[220:223], a[76:79]
    ds_read_b128 a[112:115], v120 offset:0
    v_mov_b32_dpp v14, v150 row_ror:8 row_mask:0xf bank_mask:0xf
    v_mfma_f32_16x16x32_bf16 a[72:75], a[124:127], v[216:219], a[72:75]
    v_mov_b32_dpp v15, v151 row_ror:8 row_mask:0xf bank_mask:0xf
    v_perm_b32 v233, v14, v150, v4
    v_mfma_f32_16x16x32_bf16 a[72:75], a[120:123], v[200:203], a[72:75]
    v_perm_b32 v237, v15, v151, v4
    v_mov_b32_dpp v12, v152 row_ror:8 row_mask:0xf bank_mask:0xf
    v_mfma_f32_16x16x32_bf16 a[68:71], a[120:123], v[196:199], a[68:71]
    buffer_load_dwordx4 v[188:191], v3, s[32:35], s83 offen offset:2048
    v_mfma_f32_16x16x32_bf16 a[68:71], a[124:127], v[212:215], a[68:71]
    ds_read_b128 a[116:119], v120 offset:16
    v_mov_b32_dpp v13, v153 row_ror:8 row_mask:0xf bank_mask:0xf
    v_mfma_f32_16x16x32_bf16 a[64:67], a[124:127], v[208:211], a[64:67]
    v_perm_b32 v226, v12, v152, v4
    v_perm_b32 v230, v13, v153, v4
    v_mfma_f32_16x16x32_bf16 a[64:67], a[120:123], v[192:195], a[64:67]
    s_waitcnt vmcnt(8) lgkmcnt(13)
    v_mov_b32_dpp v14, v154 row_ror:8 row_mask:0xf bank_mask:0xf
    v_mov_b32_dpp v15, v155 row_ror:8 row_mask:0xf bank_mask:0xf
    v_mfma_f32_16x16x32_bf16 a[80:83], a[128:131], v[192:195], a[80:83]
    buffer_store_dwordx4 v[92:95], v5, s[36:39], s91 offen offset:0 sc1
    v_mfma_f32_16x16x32_bf16 a[80:83], a[132:135], v[208:211], a[80:83]
    ds_read_b128 a[120:123], v120 offset:32
    v_perm_b32 v234, v14, v154, v4
    v_mfma_f32_16x16x32_bf16 a[84:87], a[132:135], v[212:215], a[84:87]
    v_perm_b32 v238, v15, v155, v4
    v_mov_b32_dpp v12, v156 row_ror:8 row_mask:0xf bank_mask:0xf
    v_mfma_f32_16x16x32_bf16 a[84:87], a[128:131], v[196:199], a[84:87]
    v_mov_b32_dpp v13, v157 row_ror:8 row_mask:0xf bank_mask:0xf
    v_perm_b32 v227, v12, v156, v4
    v_mfma_f32_16x16x32_bf16 a[88:91], a[128:131], v[200:203], a[88:91]
    buffer_store_dwordx4 v[92:95], v5, s[36:39], s91 offen offset:1024 sc1
    v_mfma_f32_16x16x32_bf16 a[88:91], a[132:135], v[216:219], a[88:91]
    ds_read_b128 a[124:127], v120 offset:48
    v_perm_b32 v231, v13, v157, v4
    v_mfma_f32_16x16x32_bf16 a[92:95], a[132:135], v[220:223], a[92:95]
    v_mov_b32_dpp v14, v158 row_ror:8 row_mask:0xf bank_mask:0xf
    v_mov_b32_dpp v15, v159 row_ror:8 row_mask:0xf bank_mask:0xf
    v_mfma_f32_16x16x32_bf16 a[92:95], a[128:131], v[204:207], a[92:95]
    s_waitcnt vmcnt(8) lgkmcnt(13)
    v_perm_b32 v235, v14, v158, v4
    v_perm_b32 v239, v15, v159, v4
    v_mfma_f32_16x16x32_bf16 v[44:47], a[136:139], v[204:207], v[44:47]
    buffer_store_dwordx4 v[92:95], v5, s[36:39], s91 offen offset:2048 sc1
    v_mfma_f32_16x16x32_bf16 v[44:47], a[140:143], v[220:223], v[44:47]
    ds_read_b128 a[128:131], v121 offset:0
    v_mov_b32_dpp v12, v160 row_ror:8 row_mask:0xf bank_mask:0xf
    v_mfma_f32_16x16x32_bf16 v[40:43], a[140:143], v[216:219], v[40:43]
    v_mov_b32_dpp v13, v161 row_ror:8 row_mask:0xf bank_mask:0xf
    v_perm_b32 v144, v12, v160, v4
    v_mfma_f32_16x16x32_bf16 v[40:43], a[136:139], v[200:203], v[40:43]
    v_perm_b32 v148, v13, v161, v4
    v_mov_b32_dpp v14, v162 row_ror:8 row_mask:0xf bank_mask:0xf
    v_mfma_f32_16x16x32_bf16 v[36:39], a[136:139], v[196:199], v[36:39]
    buffer_store_dwordx4 v[92:95], v5, s[36:39], s91 offen offset:3072 sc1
    v_mfma_f32_16x16x32_bf16 v[36:39], a[140:143], v[212:215], v[36:39]
    ds_read_b128 a[132:135], v121 offset:16
    v_mov_b32_dpp v15, v163 row_ror:8 row_mask:0xf bank_mask:0xf
    v_mfma_f32_16x16x32_bf16 v[32:35], a[140:143], v[208:211], v[32:35]
    v_perm_b32 v152, v14, v162, v4
    v_perm_b32 v156, v15, v163, v4
    v_mfma_f32_16x16x32_bf16 v[32:35], a[136:139], v[192:195], v[32:35]
    s_waitcnt vmcnt(9) lgkmcnt(12)
    ds_read_b128 v[92:95], v125 offset:0
    v_mov_b32_dpp v12, v164 row_ror:8 row_mask:0xf bank_mask:0xf
    v_mfma_f32_16x16x32_bf16 a[0:3], v[208:211], a[144:147], a[0:3]
    v_mov_b32_dpp v13, v165 row_ror:8 row_mask:0xf bank_mask:0xf
    v_perm_b32 v145, v12, v164, v4
    v_mfma_f32_16x16x32_bf16 a[0:3], v[48:51], a[148:151], a[0:3]
    ds_read_b128 a[136:139], v121 offset:32
    v_perm_b32 v149, v13, v165, v4
    v_mfma_f32_16x16x32_bf16 a[4:7], v[52:55], a[148:151], a[4:7]
    v_mov_b32_dpp v14, v166 row_ror:8 row_mask:0xf bank_mask:0xf
    v_mov_b32_dpp v15, v167 row_ror:8 row_mask:0xf bank_mask:0xf
    v_mfma_f32_16x16x32_bf16 a[4:7], v[212:215], a[144:147], a[4:7]
    v_perm_b32 v153, v14, v166, v4
    v_perm_b32 v157, v15, v167, v4
    v_mfma_f32_16x16x32_bf16 a[8:11], v[216:219], a[144:147], a[8:11]
    v_mov_b32_dpp v12, v168 row_ror:8 row_mask:0xf bank_mask:0xf
    v_mov_b32_dpp v13, v169 row_ror:8 row_mask:0xf bank_mask:0xf
    v_mfma_f32_16x16x32_bf16 a[8:11], v[56:59], a[148:151], a[8:11]
    ds_read_b128 a[140:143], v121 offset:48
    v_perm_b32 v146, v12, v168, v4
    v_mfma_f32_16x16x32_bf16 a[12:15], v[60:63], a[148:151], a[12:15]
    v_perm_b32 v150, v13, v169, v4
    v_mov_b32_dpp v14, v170 row_ror:8 row_mask:0xf bank_mask:0xf
    v_mfma_f32_16x16x32_bf16 a[12:15], v[220:223], a[144:147], a[12:15]
    s_waitcnt vmcnt(7) lgkmcnt(13)
    ds_read_b128 v[192:195], v119 offset:48
    v_mov_b32_dpp v15, v171 row_ror:8 row_mask:0xf bank_mask:0xf
    v_mfma_f32_16x16x32_bf16 a[28:31], v[220:223], a[152:155], a[28:31]
    v_perm_b32 v154, v14, v170, v4
    v_perm_b32 v158, v15, v171, v4
    v_mfma_f32_16x16x32_bf16 a[28:31], v[60:63], a[156:159], a[28:31]
    ds_read_b128 a[144:147], v122 offset:0
    v_mov_b32_dpp v12, v172 row_ror:8 row_mask:0xf bank_mask:0xf
    v_mfma_f32_16x16x32_bf16 a[24:27], v[56:59], a[156:159], a[24:27]
    v_mov_b32_dpp v13, v173 row_ror:8 row_mask:0xf bank_mask:0xf
    v_perm_b32 v147, v12, v172, v4
    v_mfma_f32_16x16x32_bf16 a[24:27], v[216:219], a[152:155], a[24:27]
    v_perm_b32 v151, v13, v173, v4
    v_mov_b32_dpp v14, v174 row_ror:8 row_mask:0xf bank_mask:0xf
    v_mfma_f32_16x16x32_bf16 a[20:23], v[212:215], a[152:155], a[20:23]
    v_mov_b32_dpp v15, v175 row_ror:8 row_mask:0xf bank_mask:0xf
    v_perm_b32 v155, v14, v174, v4
    v_mfma_f32_16x16x32_bf16 a[20:23], v[52:55], a[156:159], a[20:23]
    ds_read_b128 a[148:151], v122 offset:16
    v_perm_b32 v159, v15, v175, v4
    v_mfma_f32_16x16x32_bf16 a[16:19], v[48:51], a[156:159], a[16:19]
    v_mov_b32_dpp v12, v176 row_ror:8 row_mask:0xf bank_mask:0xf
    v_mov_b32_dpp v13, v177 row_ror:8 row_mask:0xf bank_mask:0xf
    v_mfma_f32_16x16x32_bf16 a[16:19], v[208:211], a[152:155], a[16:19]
    s_waitcnt vmcnt(6) lgkmcnt(14)
    ds_read_b128 v[196:199], v125 offset:48
    v_perm_b32 v160, v12, v176, v4
    v_mfma_f32_16x16x32_bf16 a[32:35], a[96:99], v[208:211], a[32:35]
    v_perm_b32 v164, v13, v177, v4
    v_mov_b32_dpp v14, v178 row_ror:8 row_mask:0xf bank_mask:0xf
    v_mfma_f32_16x16x32_bf16 a[32:35], a[100:103], v[48:51], a[32:35]
    ds_read_b128 a[152:155], v122 offset:32
    v_mov_b32_dpp v15, v179 row_ror:8 row_mask:0xf bank_mask:0xf
    v_mfma_f32_16x16x32_bf16 a[36:39], a[100:103], v[52:55], a[36:39]
    v_perm_b32 v168, v14, v178, v4
    v_perm_b32 v172, v15, v179, v4
    v_mfma_f32_16x16x32_bf16 a[36:39], a[96:99], v[212:215], a[36:39]
    v_mov_b32_dpp v12, v180 row_ror:8 row_mask:0xf bank_mask:0xf
    v_mov_b32_dpp v13, v181 row_ror:8 row_mask:0xf bank_mask:0xf
    v_mfma_f32_16x16x32_bf16 a[40:43], a[96:99], v[216:219], a[40:43]
    v_perm_b32 v161, v12, v180, v4
    v_perm_b32 v165, v13, v181, v4
    v_mfma_f32_16x16x32_bf16 a[40:43], a[100:103], v[56:59], a[40:43]
    ds_read_b128 a[156:159], v122 offset:48
    v_mov_b32_dpp v14, v182 row_ror:8 row_mask:0xf bank_mask:0xf
    v_mfma_f32_16x16x32_bf16 a[44:47], a[100:103], v[60:63], a[44:47]
    v_mov_b32_dpp v15, v183 row_ror:8 row_mask:0xf bank_mask:0xf
    v_perm_b32 v169, v14, v182, v4
    v_mfma_f32_16x16x32_bf16 a[44:47], a[96:99], v[220:223], a[44:47]
    s_waitcnt vmcnt(4) lgkmcnt(14)
    ds_read_b128 v[200:203], v125 offset:32
    v_perm_b32 v173, v15, v183, v4
    v_mfma_f32_16x16x32_bf16 v[28:31], a[104:107], v[220:223], v[28:31]
    v_mov_b32_dpp v12, v184 row_ror:8 row_mask:0xf bank_mask:0xf
    v_mov_b32_dpp v13, v185 row_ror:8 row_mask:0xf bank_mask:0xf
    v_mfma_f32_16x16x32_bf16 v[28:31], a[108:111], v[60:63], v[28:31]
    ds_read_b128 a[96:99], v126 offset:0
    v_perm_b32 v162, v12, v184, v4
    v_mfma_f32_16x16x32_bf16 v[24:27], a[108:111], v[56:59], v[24:27]
    v_perm_b32 v166, v13, v185, v4
    v_mov_b32_dpp v14, v186 row_ror:8 row_mask:0xf bank_mask:0xf
    v_mfma_f32_16x16x32_bf16 v[24:27], a[104:107], v[216:219], v[24:27]
    v_mov_b32_dpp v15, v187 row_ror:8 row_mask:0xf bank_mask:0xf
    v_perm_b32 v170, v14, v186, v4
    v_mfma_f32_16x16x32_bf16 v[20:23], a[104:107], v[212:215], v[20:23]
    v_perm_b32 v174, v15, v187, v4
    v_mov_b32_dpp v12, v188 row_ror:8 row_mask:0xf bank_mask:0xf
    v_mfma_f32_16x16x32_bf16 v[20:23], a[108:111], v[52:55], v[20:23]
    ds_read_b128 a[100:103], v126 offset:16
    v_mov_b32_dpp v13, v189 row_ror:8 row_mask:0xf bank_mask:0xf
    v_mfma_f32_16x16x32_bf16 v[16:19], a[108:111], v[48:51], v[16:19]
    v_perm_b32 v163, v12, v188, v4
    v_perm_b32 v167, v13, v189, v4
    v_mfma_f32_16x16x32_bf16 v[16:19], a[104:107], v[208:211], v[16:19]
    s_waitcnt lgkmcnt(14)
    ds_read_b128 v[204:207], v125 offset:16
    v_mov_b32_dpp v14, v190 row_ror:8 row_mask:0xf bank_mask:0xf
    v_mfma_f32_16x16x32_bf16 a[0:3], v[64:67], a[112:115], a[0:3]
    v_mov_b32_dpp v15, v191 row_ror:8 row_mask:0xf bank_mask:0xf
    v_perm_b32 v171, v14, v190, v4
    v_mfma_f32_16x16x32_bf16 a[0:3], v[224:227], a[116:119], a[0:3]
    ds_read_b128 a[104:107], v126 offset:32
    v_perm_b32 v175, v15, v191, v4
    v_mfma_f32_16x16x32_bf16 a[0:3], v[144:147], a[120:123], a[0:3]
    v_mfma_f32_16x16x32_bf16 a[0:3], v[160:163], a[124:127], a[0:3]
    v_mfma_f32_16x16x32_bf16 a[4:7], v[164:167], a[124:127], a[4:7]
    v_mfma_f32_16x16x32_bf16 a[4:7], v[148:151], a[120:123], a[4:7]
    ds_read_b128 a[108:111], v126 offset:48
    v_mfma_f32_16x16x32_bf16 a[4:7], v[228:231], a[116:119], a[4:7]
    v_accvgpr_read_b32 v12, a0
    v_accvgpr_read_b32 v13, a1
    v_mfma_f32_16x16x32_bf16 a[4:7], v[68:71], a[112:115], a[4:7]
    ds_write_addtid_b32 v12 offset:768
    v_accvgpr_read_b32 v14, a2
    v_mfma_f32_16x16x32_bf16 a[8:11], v[72:75], a[112:115], a[8:11]
    ds_write_addtid_b32 v13 offset:8992
    v_accvgpr_read_b32 v15, a3
    v_mfma_f32_16x16x32_bf16 a[8:11], v[232:235], a[116:119], a[8:11]
    ds_write_addtid_b32 v14 offset:17280
    v_mfma_f32_16x16x32_bf16 a[8:11], v[152:155], a[120:123], a[8:11]
    ds_write_addtid_b32 v15 offset:25504
    v_accvgpr_read_b32 v12, a4
    v_mfma_f32_16x16x32_bf16 a[8:11], v[168:171], a[124:127], a[8:11]
    ds_write_addtid_b32 v12 offset:1792
    v_accvgpr_read_b32 v13, a5
    v_mfma_f32_16x16x32_bf16 a[12:15], v[172:175], a[124:127], a[12:15]
    ds_write_addtid_b32 v13 offset:10016
    v_accvgpr_read_b32 v14, a6
    v_mfma_f32_16x16x32_bf16 a[12:15], v[156:159], a[120:123], a[12:15]
    ds_write_addtid_b32 v14 offset:18304
    v_accvgpr_read_b32 v15, a7
    v_mfma_f32_16x16x32_bf16 a[12:15], v[236:239], a[116:119], a[12:15]
    ds_write_addtid_b32 v15 offset:26528
    v_accvgpr_read_b32 v12, a8
    v_mfma_f32_16x16x32_bf16 a[12:15], v[76:79], a[112:115], a[12:15]
    s_waitcnt lgkmcnt(14)
    ds_write_addtid_b32 v12 offset:2816
    v_accvgpr_read_b32 v13, a9
    v_mfma_f32_16x16x32_bf16 a[16:19], v[64:67], a[128:131], a[16:19]
    ds_write_addtid_b32 v13 offset:11040
    v_accvgpr_read_b32 v14, a10
    v_mfma_f32_16x16x32_bf16 a[16:19], v[224:227], a[132:135], a[16:19]
    ds_read_b128 a[112:115], v115 offset:48
    v_accvgpr_read_b32 v15, a11
    v_mfma_f32_16x16x32_bf16 a[16:19], v[144:147], a[136:139], a[16:19]
    ds_write_addtid_b32 v14 offset:19328
    v_accvgpr_read_b32 v12, a12
    v_mfma_f32_16x16x32_bf16 a[16:19], v[160:163], a[140:143], a[16:19]
    ds_write_addtid_b32 v15 offset:27552
    v_accvgpr_read_b32 v13, a13
    v_mfma_f32_16x16x32_bf16 a[20:23], v[164:167], a[140:143], a[20:23]
    ds_write_addtid_b32 v12 offset:3840
    v_accvgpr_read_b32 v14, a14
    v_mfma_f32_16x16x32_bf16 a[20:23], v[148:151], a[136:139], a[20:23]
    ds_write_addtid_b32 v13 offset:12064
    v_accvgpr_read_b32 v15, a15
    v_mfma_f32_16x16x32_bf16 a[20:23], v[228:231], a[132:135], a[20:23]
    ds_read_b128 a[116:119], v123 offset:0
    v_accvgpr_read_b32 v12, a16
    v_mfma_f32_16x16x32_bf16 a[20:23], v[68:71], a[128:131], a[20:23]
    ds_write_addtid_b32 v14 offset:20352
    v_accvgpr_read_b32 v13, a17
    v_mfma_f32_16x16x32_bf16 a[24:27], v[72:75], a[128:131], a[24:27]
    ds_write_addtid_b32 v15 offset:28576
    v_accvgpr_read_b32 v14, a18
    v_mfma_f32_16x16x32_bf16 a[24:27], v[232:235], a[132:135], a[24:27]
    s_xor_b32 m0, m0, 0x100
    v_accvgpr_read_b32 v15, a19
    v_mfma_f32_16x16x32_bf16 a[24:27], v[152:155], a[136:139], a[24:27]
    ds_read_b128 a[120:123], v123 offset:16
    ds_write_addtid_b32 v12 offset:4864
    v_mfma_f32_16x16x32_bf16 a[24:27], v[168:171], a[140:143], a[24:27]
    ds_write_addtid_b32 v13 offset:13088
    v_accvgpr_read_b32 v12, a20
    v_mfma_f32_16x16x32_bf16 a[28:31], v[172:175], a[140:143], a[28:31]
    ds_write_addtid_b32 v14 offset:21376
    v_accvgpr_read_b32 v13, a21
    v_mfma_f32_16x16x32_bf16 a[28:31], v[156:159], a[136:139], a[28:31]
    ds_write_addtid_b32 v15 offset:29600
    v_accvgpr_read_b32 v14, a22
    v_mfma_f32_16x16x32_bf16 a[28:31], v[236:239], a[132:135], a[28:31]
    ds_write_addtid_b32 v12 offset:5888
    v_accvgpr_read_b32 v15, a23
    v_mfma_f32_16x16x32_bf16 a[28:31], v[76:79], a[128:131], a[28:31]
    ds_read_b128 a[124:127], v123 offset:32
    ds_write_addtid_b32 v13 offset:14112
    v_mfma_f32_16x16x32_bf16 a[32:35], a[144:147], v[64:67], a[32:35]
    ds_write_addtid_b32 v14 offset:22400
    v_accvgpr_read_b32 v12, a24
    v_mfma_f32_16x16x32_bf16 a[32:35], a[148:151], v[224:227], a[32:35]
    ds_write_addtid_b32 v15 offset:30624
    v_accvgpr_read_b32 v13, a25
    v_mfma_f32_16x16x32_bf16 a[32:35], a[152:155], v[144:147], a[32:35]
    ds_write_addtid_b32 v12 offset:6912
    v_accvgpr_read_b32 v14, a26
    v_mfma_f32_16x16x32_bf16 a[32:35], a[156:159], v[160:163], a[32:35]
    ds_write_addtid_b32 v13 offset:15136
    v_accvgpr_read_b32 v15, a27
    v_mfma_f32_16x16x32_bf16 a[36:39], a[156:159], v[164:167], a[36:39]
    ds_read_b128 a[128:131], v123 offset:48
    v_accvgpr_read_b32 v12, a28
    v_mfma_f32_16x16x32_bf16 a[36:39], a[152:155], v[148:151], a[36:39]
    ds_write_addtid_b32 v14 offset:23424
    v_accvgpr_read_b32 v13, a29
    v_mfma_f32_16x16x32_bf16 a[36:39], a[148:151], v[228:231], a[36:39]
    ds_write_addtid_b32 v15 offset:31648
    v_accvgpr_read_b32 v14, a30
    v_mfma_f32_16x16x32_bf16 a[36:39], a[144:147], v[68:71], a[36:39]
    ds_write_addtid_b32 v12 offset:7936
    v_accvgpr_read_b32 v15, a31
    v_mfma_f32_16x16x32_bf16 a[40:43], a[144:147], v[72:75], a[40:43]
    ds_write_addtid_b32 v13 offset:16160
    v_mfma_f32_16x16x32_bf16 a[40:43], a[148:151], v[232:235], a[40:43]
    ds_write_addtid_b32 v14 offset:24448
    v_mfma_f32_16x16x32_bf16 a[40:43], a[152:155], v[152:155], a[40:43]
    ds_write_addtid_b32 v15 offset:32672
    v_mfma_f32_16x16x32_bf16 a[40:43], a[156:159], v[168:171], a[40:43]
    v_mfma_f32_16x16x32_bf16 a[44:47], a[156:159], v[172:175], a[44:47]
    v_mfma_f32_16x16x32_bf16 a[44:47], a[152:155], v[156:159], a[44:47]
    s_waitcnt lgkmcnt(0)
    s_barrier
    v_mfma_f32_16x16x32_bf16 a[44:47], a[148:151], v[236:239], a[44:47]
    v_mfma_f32_16x16x32_bf16 a[44:47], a[144:147], v[76:79], a[44:47]
    ds_read_b128 v[208:211], v7 offset:0
    v_mfma_f32_16x16x32_bf16 v[16:19], a[96:99], v[64:67], v[16:19]
    ds_read_b128 v[212:215], v7 offset:1024
    ds_read_b128 v[216:219], v7 offset:2048
    v_mfma_f32_16x16x32_bf16 v[16:19], a[100:103], v[224:227], v[16:19]
    ds_read_b128 v[220:223], v7 offset:3072
    ds_read_b128 v[176:179], v7 offset:4096
    v_mfma_f32_16x16x32_bf16 v[16:19], a[104:107], v[144:147], v[16:19]
    ds_read_b128 v[180:183], v7 offset:5120
    ds_read_b128 v[184:187], v7 offset:6144
    v_mfma_f32_16x16x32_bf16 v[16:19], a[108:111], v[160:163], v[16:19]
    ds_read_b128 v[188:191], v7 offset:7168
    v_mfma_f32_16x16x32_bf16 v[20:23], a[108:111], v[164:167], v[20:23]
    v_mfma_f32_16x16x32_bf16 v[20:23], a[104:107], v[148:151], v[20:23]
    s_waitcnt lgkmcnt(5)
    v_add_f32 v24, v24, v216
    v_add_f32 v25, v25, v217
    v_mfma_f32_16x16x32_bf16 v[20:23], a[100:103], v[228:231], v[20:23]
    ds_write_b128 v246, a[32:35] offset:32768
    v_mfma_f32_16x16x32_bf16 v[20:23], a[96:99], v[68:71], v[20:23]
    v_add_f32 v16, v16, v208
    v_add_f32 v17, v17, v209
    v_mfma_f32_16x16x32_bf16 v[24:27], a[96:99], v[72:75], v[24:27]
    buffer_load_dword v249, v248, s[36:39], s7 offen sc1
    v_mfma_f32_16x16x32_bf16 v[24:27], a[100:103], v[232:235], v[24:27]
    ds_write_b128 v246, a[36:39] offset:36864
    v_mfma_f32_16x16x32_bf16 v[24:27], a[104:107], v[152:155], v[24:27]
    v_add_f32 v18, v18, v210
    v_add_f32 v19, v19, v211
    v_mfma_f32_16x16x32_bf16 v[24:27], a[108:111], v[168:171], v[24:27]
    v_add_f32 v20, v20, v212
    v_add_f32 v21, v21, v213
    v_mfma_f32_16x16x32_bf16 v[28:31], a[108:111], v[172:175], v[28:31]
    ds_write_b128 v246, a[40:43] offset:40960
    v_mfma_f32_16x16x32_bf16 v[28:31], a[104:107], v[156:159], v[28:31]
    v_add_f32 v22, v22, v214
    v_add_f32 v23, v23, v215
    v_mfma_f32_16x16x32_bf16 v[28:31], a[100:103], v[236:239], v[28:31]
    v_add_f32 v26, v26, v218
    v_add_f32 v27, v27, v219
    v_mfma_f32_16x16x32_bf16 v[28:31], a[96:99], v[76:79], v[28:31]
    ds_write_b128 v246, a[44:47] offset:45056
    v_mfma_f32_16x16x32_bf16 a[48:51], a[112:115], v[48:51], a[48:51]
    s_waitcnt lgkmcnt(4)
    v_add_f32 v16, v16, v176
    v_add_f32 v17, v17, v177
    v_mfma_f32_16x16x32_bf16 a[48:51], a[116:119], v[64:67], a[48:51]
    v_add_f32 v18, v18, v178
    v_add_f32 v19, v19, v179
    v_mfma_f32_16x16x32_bf16 a[48:51], a[120:123], v[224:227], a[48:51]
    v_add_f32 v28, v28, v220
    v_add_f32 v29, v29, v221
    v_mfma_f32_16x16x32_bf16 a[48:51], a[124:127], v[144:147], a[48:51]
    s_waitcnt lgkmcnt(0)
    s_barrier
    ds_read_b128 v[208:211], v8 offset:32768
    v_mfma_f32_16x16x32_bf16 a[48:51], a[128:131], v[160:163], a[48:51]
    ds_read_b128 v[212:215], v8 offset:36864
    ds_read_b128 v[216:219], v8 offset:40960
    v_mfma_f32_16x16x32_bf16 a[52:55], a[128:131], v[164:167], a[52:55]
    v_add_f32 v30, v30, v222
    v_add_f32 v31, v31, v223
    v_mfma_f32_16x16x32_bf16 a[52:55], a[124:127], v[148:151], a[52:55]
    ds_read_b128 a[132:135], v116 offset:48
    v_add_f32 v20, v20, v180
    v_mfma_f32_16x16x32_bf16 a[52:55], a[120:123], v[228:231], a[52:55]
    ds_read_b128 v[220:223], v8 offset:45056
    v_add_f32 v21, v21, v181
    v_mfma_f32_16x16x32_bf16 a[52:55], a[116:119], v[68:71], a[52:55]
    ds_read_b128 a[136:139], v124 offset:0
    v_add_f32 v22, v22, v182
    v_mfma_f32_16x16x32_bf16 a[52:55], a[112:115], v[52:55], a[52:55]
    v_add_f32 v23, v23, v183
    v_add_f32 v24, v24, v184
    v_mfma_f32_16x16x32_bf16 a[56:59], a[112:115], v[56:59], a[56:59]
    v_add_f32 v25, v25, v185
    v_add_f32 v26, v26, v186
    v_mfma_f32_16x16x32_bf16 a[56:59], a[116:119], v[72:75], a[56:59]
    v_add_f32 v27, v27, v187
    v_add_f32 v28, v28, v188
    v_mfma_f32_16x16x32_bf16 a[56:59], a[120:123], v[232:235], a[56:59]
    ds_write_b128 v10, a[48:51] offset:49152
    v_mfma_f32_16x16x32_bf16 a[56:59], a[124:127], v[152:155], a[56:59]
    v_add_f32 v29, v29, v189
    v_add_f32 v30, v30, v190
    v_mfma_f32_16x16x32_bf16 a[56:59], a[128:131], v[168:171], a[56:59]
    s_waitcnt lgkmcnt(2)
    v_add_f32 v31, v31, v191
    v_add_f32 v16, v16, v208
    v_mfma_f32_16x16x32_bf16 a[60:63], a[128:131], v[172:175], a[60:63]
    ds_write_b128 v10, a[52:55] offset:53248
    v_mfma_f32_16x16x32_bf16 a[60:63], a[124:127], v[156:159], a[60:63]
    v_add_f32 v17, v17, v209
    v_add_f32 v18, v18, v210
    v_mfma_f32_16x16x32_bf16 a[60:63], a[120:123], v[236:239], a[60:63]
    v_add_f32 v19, v19, v211
    v_add_f32 v20, v20, v212
    v_mfma_f32_16x16x32_bf16 a[60:63], a[116:119], v[76:79], a[60:63]
    ds_write_b128 v10, a[56:59] offset:57344
    v_mfma_f32_16x16x32_bf16 a[60:63], a[112:115], v[60:63], a[60:63]
    v_cvt_pk_bf16_f32 v16, v16, v20
    v_add_f32 v21, v21, v213
    v_mfma_f32_16x16x32_bf16 a[64:67], a[132:135], v[48:51], a[64:67]
    s_waitcnt lgkmcnt(3)
    v_cvt_pk_bf16_f32 v17, v17, v21
    v_add_f32 v22, v22, v214
    v_mfma_f32_16x16x32_bf16 a[64:67], a[136:139], v[64:67], a[64:67]
    v_cvt_pk_bf16_f32 v20, v18, v22
    v_add_f32 v23, v23, v215
    v_mfma_f32_16x16x32_bf16 a[64:67], v[108:111], v[224:227], a[64:67]
    ds_write_b128 v10, a[60:63] offset:61440
    v_mfma_f32_16x16x32_bf16 a[64:67], v[104:107], v[144:147], a[64:67]
    v_cvt_pk_bf16_f32 v21, v19, v23
    v_add_f32 v24, v24, v216
    v_mfma_f32_16x16x32_bf16 a[64:67], v[100:103], v[160:163], a[64:67]
    v_add_f32 v25, v25, v217
    v_add_f32 v26, v26, v218
    v_mfma_f32_16x16x32_bf16 a[68:71], v[100:103], v[164:167], a[68:71]
    v_add_f32 v27, v27, v219
    v_add_f32 v28, v28, v220
    v_mfma_f32_16x16x32_bf16 a[68:71], v[104:107], v[148:151], a[68:71]
    s_waitcnt lgkmcnt(0)
    s_barrier
    ds_read_b128 v[176:179], v8 offset:49152
    v_mfma_f32_16x16x32_bf16 a[68:71], v[108:111], v[228:231], a[68:71]
    ds_read_b128 v[180:183], v8 offset:53248
    ds_read_b128 v[184:187], v8 offset:57344
    v_mfma_f32_16x16x32_bf16 a[68:71], a[136:139], v[68:71], a[68:71]
    ds_read_b128 v[188:191], v8 offset:61440
    v_cvt_pk_bf16_f32 v18, v24, v28
    v_mfma_f32_16x16x32_bf16 a[68:71], a[132:135], v[52:55], a[68:71]
    v_add_f32 v29, v29, v221
    v_add_f32 v30, v30, v222
    v_mfma_f32_16x16x32_bf16 a[72:75], a[132:135], v[56:59], a[72:75]
    ds_write_b128 v245, a[64:67] offset:0
    v_mfma_f32_16x16x32_bf16 a[72:75], a[136:139], v[72:75], a[72:75]
    v_cvt_pk_bf16_f32 v19, v25, v29
    v_cvt_pk_bf16_f32 v22, v26, v30
    v_mfma_f32_16x16x32_bf16 a[72:75], v[108:111], v[232:235], a[72:75]
    s_waitcnt vmcnt(0)
    v_cmp_ne_u32 vcc, s12, v249
    v_add_f32 v31, v31, v223
    v_mfma_f32_16x16x32_bf16 a[72:75], v[104:107], v[152:155], a[72:75]
    s_cbranch_vccnz L_r1
L_r1b:
    v_mfma_f32_16x16x32_bf16 a[72:75], v[100:103], v[168:171], a[72:75]
    ds_write_b128 v245, a[68:71] offset:4096
    v_mfma_f32_16x16x32_bf16 a[76:79], v[100:103], v[172:175], a[76:79]
    buffer_store_dwordx4 v[16:19], v241, s[36:39], s7 offen offset:0 sc1
    v_mfma_f32_16x16x32_bf16 a[76:79], v[104:107], v[156:159], a[76:79]
    s_waitcnt lgkmcnt(2)
    v_cvt_pk_bf16_f32 v23, v27, v31
    v_add_f32 v32, v32, v176
    v_mfma_f32_16x16x32_bf16 a[76:79], v[108:111], v[236:239], a[76:79]
    ds_write_b128 v245, a[72:75] offset:8192
    v_mfma_f32_16x16x32_bf16 a[76:79], a[136:139], v[76:79], a[76:79]
    buffer_store_dwordx4 v[20:23], v241, s[36:39], s19 offen offset:0 sc1
    v_mfma_f32_16x16x32_bf16 a[76:79], a[132:135], v[60:63], a[76:79]
    v_add_f32 v33, v33, v177
    v_add_f32 v34, v34, v178
    v_mfma_f32_16x16x32_bf16 a[80:83], v[96:99], v[48:51], a[80:83]
    v_add_f32 v35, v35, v179
    v_add_f32 v36, v36, v180
    v_mfma_f32_16x16x32_bf16 a[80:83], v[92:95], v[64:67], a[80:83]
    v_add_f32 v37, v37, v181
    v_add_f32 v38, v38, v182
    v_mfma_f32_16x16x32_bf16 a[80:83], v[204:207], v[224:227], a[80:83]
    ds_write_b128 v245, a[76:79] offset:12288
    v_mfma_f32_16x16x32_bf16 a[80:83], v[200:203], v[144:147], a[80:83]
    v_add_f32 v39, v39, v183
    v_add_f32 v40, v40, v184
    v_mfma_f32_16x16x32_bf16 a[80:83], v[196:199], v[160:163], a[80:83]
    v_add_f32 v41, v41, v185
    v_add_f32 v42, v42, v186
    v_mfma_f32_16x16x32_bf16 a[84:87], v[196:199], v[164:167], a[84:87]
    v_add_f32 v43, v43, v187
    v_add_f32 v44, v44, v188
    v_mfma_f32_16x16x32_bf16 a[84:87], v[200:203], v[148:151], a[84:87]
    s_waitcnt lgkmcnt(0)
    s_barrier
    ds_read_b128 v[208:211], v8 offset:0
    v_mfma_f32_16x16x32_bf16 a[84:87], v[204:207], v[228:231], a[84:87]
    ds_read_b128 v[212:215], v8 offset:4096
    ds_read_b128 v[216:219], v8 offset:8192
    v_mfma_f32_16x16x32_bf16 a[84:87], v[92:95], v[68:71], a[84:87]
    ds_read_b128 v[220:223], v8 offset:12288
    v_add_f32 v45, v45, v189
    v_mfma_f32_16x16x32_bf16 a[84:87], v[96:99], v[52:55], a[84:87]
    v_add_f32 v46, v46, v190
    v_add_f32 v47, v47, v191
    v_mfma_f32_16x16x32_bf16 a[88:91], v[96:99], v[56:59], a[88:91]
    ds_write_b128 v246, a[80:83] offset:16384
    v_mfma_f32_16x16x32_bf16 a[88:91], v[92:95], v[72:75], a[88:91]
    s_waitcnt lgkmcnt(4)
    v_add_f32 v32, v32, v208
    v_add_f32 v33, v33, v209
    v_mfma_f32_16x16x32_bf16 a[88:91], v[204:207], v[232:235], a[88:91]
    v_add_f32 v34, v34, v210
    v_add_f32 v35, v35, v211
    v_mfma_f32_16x16x32_bf16 a[88:91], v[200:203], v[152:155], a[88:91]
    ds_write_b128 v246, a[84:87] offset:20480
    v_mfma_f32_16x16x32_bf16 a[88:91], v[196:199], v[168:171], a[88:91]
    s_waitcnt lgkmcnt(2)
    v_add_f32 v36, v36, v212
    v_add_f32 v37, v37, v213
    v_mfma_f32_16x16x32_bf16 a[92:95], v[196:199], v[172:175], a[92:95]
    v_add_f32 v38, v38, v214
    v_add_f32 v39, v39, v215
    v_mfma_f32_16x16x32_bf16 a[92:95], v[200:203], v[156:159], a[92:95]
    v_add_f32 v40, v40, v216
    v_add_f32 v41, v41, v217
    v_mfma_f32_16x16x32_bf16 a[92:95], v[204:207], v[236:239], a[92:95]
    ds_write_b128 v246, a[88:91] offset:24576
    v_mfma_f32_16x16x32_bf16 a[92:95], v[92:95], v[76:79], a[92:95]
    v_add_f32 v42, v42, v218
    v_add_f32 v43, v43, v219
    v_mfma_f32_16x16x32_bf16 a[92:95], v[96:99], v[60:63], a[92:95]
    v_add_f32 v44, v44, v220
    v_add_f32 v45, v45, v221
    v_mfma_f32_16x16x32_bf16 v[32:35], v[192:195], v[48:51], v[32:35]
    v_add_f32 v46, v46, v222
    v_add_f32 v47, v47, v223
    v_mfma_f32_16x16x32_bf16 v[32:35], v[132:135], v[64:67], v[32:35]
L_pg5:
    s_cbranch_execz L_pgq
    v_mfma_f32_16x16x32_bf16 v[32:35], v[128:131], v[224:227], v[32:35]
    ds_write_b128 v246, a[92:95] offset:28672
    v_mfma_f32_16x16x32_bf16 v[32:35], v[140:143], v[144:147], v[32:35]
    v_mfma_f32_16x16x32_bf16 v[32:35], v[136:139], v[160:163], v[32:35]
    v_mfma_f32_16x16x32_bf16 v[36:39], v[136:139], v[164:167], v[36:39]
    v_mfma_f32_16x16x32_bf16 v[36:39], v[140:143], v[148:151], v[36:39]
    s_waitcnt lgkmcnt(0)
    s_barrier
    ds_read_b128 v[188:191], v8 offset:28672
    v_mfma_f32_16x16x32_bf16 v[36:39], v[128:131], v[228:231], v[36:39]
    ds_read_b128 v[176:179], v8 offset:16384
    ds_read_b128 v[180:183], v8 offset:20480
    v_mfma_f32_16x16x32_bf16 v[36:39], v[132:135], v[68:71], v[36:39]
    ds_read_b128 v[184:187], v8 offset:24576
    v_mfma_f32_16x16x32_bf16 v[36:39], v[192:195], v[52:55], v[36:39]
    v_mfma_f32_16x16x32_bf16 v[40:43], v[192:195], v[56:59], v[40:43]
    v_mfma_f32_16x16x32_bf16 v[40:43], v[132:135], v[72:75], v[40:43]
    s_waitcnt lgkmcnt(3)
    v_add_f32 v44, v44, v188
    v_add_f32 v45, v45, v189
    v_mfma_f32_16x16x32_bf16 v[40:43], v[128:131], v[232:235], v[40:43]
    v_add_f32 v46, v46, v190
    v_add_f32 v47, v47, v191
    v_mfma_f32_16x16x32_bf16 v[40:43], v[140:143], v[152:155], v[40:43]
    s_waitcnt lgkmcnt(0)
    v_add_f32 v32, v32, v176
    v_add_f32 v33, v33, v177
    v_mfma_f32_16x16x32_bf16 v[40:43], v[136:139], v[168:171], v[40:43]
    v_add_f32 v34, v34, v178
    v_add_f32 v35, v35, v179
    v_mfma_f32_16x16x32_bf16 v[44:47], v[136:139], v[172:175], v[44:47]
    v_add_f32 v36, v36, v180
    v_add_f32 v37, v37, v181
    v_mfma_f32_16x16x32_bf16 v[44:47], v[140:143], v[156:159], v[44:47]
    v_cvt_pk_bf16_f32 v32, v32, v36
    v_cvt_pk_bf16_f32 v33, v33, v37
    v_mfma_f32_16x16x32_bf16 v[44:47], v[128:131], v[236:239], v[44:47]
    v_add_f32 v38, v38, v182
    v_add_f32 v39, v39, v183
    v_mfma_f32_16x16x32_bf16 v[44:47], v[132:135], v[76:79], v[44:47]
    v_cvt_pk_bf16_f32 v36, v34, v38
    v_cvt_pk_bf16_f32 v37, v35, v39
    v_mfma_f32_16x16x32_bf16 v[44:47], v[192:195], v[60:63], v[44:47]
    v_add_f32 v40, v40, v184
    v_add_f32 v41, v41, v185
    v_mfma_f32_16x16x32_bf16 v[48:51], a[160:163], a[160:163], 0
    v_add_f32 v42, v42, v186
    v_add_f32 v43, v43, v187
    v_mfma_f32_16x16x32_bf16 v[48:51], a[164:167], a[164:167], v[48:51]
    v_mfma_f32_16x16x32_bf16 v[48:51], a[168:171], a[168:171], v[48:51]
    v_cvt_pk_bf16_f32 v34, v40, v44
    v_cvt_pk_bf16_f32 v35, v41, v45
    v_mfma_f32_16x16x32_bf16 v[48:51], a[172:175], a[172:175], v[48:51]
    buffer_store_dwordx4 v[32:35], v241, s[36:39], s7 offen offset:2048 sc1
    v_mfma_f32_16x16x32_bf16 v[64:67], v[80:83], v[82:85], 0
    v_cvt_pk_bf16_f32 v38, v42, v46
    v_cvt_pk_bf16_f32 v39, v43, v47
    v_mfma_f32_16x16x32_bf16 v[52:55], a[176:179], a[176:179], 0
    buffer_store_dwordx4 v[36:39], v241, s[36:39], s19 offen offset:2048 sc1
    v_mfma_f32_16x16x32_bf16 v[52:55], a[180:183], a[180:183], v[52:55]
    ds_read_b64 v[84:85], v255 offset:6464
    ds_read_b64 v[80:81], v255 offset:6464
    v_mfma_f32_16x16x32_bf16 v[52:55], a[184:187], a[184:187], v[52:55]
    s_movk_i32 s97, 0x4000
    ds_read_b128 v[96:99], v6 offset:0
    v_mul_f32 v140, v48, v64
    v_mfma_f32_16x16x32_bf16 v[52:55], a[188:191], a[188:191], v[52:55]
    ds_read_b128 v[100:103], v6 offset:64
    v_mul_f32 v141, v49, v65
    v_mfma_f32_16x16x32_bf16 v[68:71], v[86:89], v[88:91], 0
    ds_read_b64 v[90:91], v255 offset:9696
    ds_read_b64 v[86:87], v255 offset:9696
    v_mfma_f32_16x16x32_bf16 v[56:59], a[192:195], a[192:195], 0
    ds_read_b128 v[104:107], v6 offset:128
    v_mul_f32 v142, v50, v66
    v_mfma_f32_16x16x32_bf16 v[56:59], a[196:199], a[196:199], v[56:59]
    ds_read_b128 v[108:111], v6 offset:192
    v_mul_f32 v143, v51, v67
    v_mfma_f32_16x16x32_bf16 v[56:59], a[200:203], a[200:203], v[56:59]
    v_fmac_f32 v140, v52, v68
    v_fmac_f32 v141, v53, v69
    v_mfma_f32_16x16x32_bf16 v[56:59], a[204:207], a[204:207], v[56:59]
    s_waitcnt lgkmcnt(6)
    v_fmac_f32 v142, v54, v70
    v_fmac_f32 v143, v55, v71
    v_mfma_f32_16x16x32_bf16 v[72:75], v[80:83], v[82:85], 0
    ds_read_b64 v[84:85], v255 offset:12928
    ds_read_b64 v[80:81], v255 offset:12928
    v_mfma_f32_16x16x32_bf16 v[60:63], a[208:211], a[208:211], 0
    ds_read_b64 v[224:225], v253 offset:0
    v_and_b32 v4, 0x03030000, v4
    v_mfma_f32_16x16x32_bf16 v[60:63], a[212:215], a[212:215], v[60:63]
    ds_read_b64 v[228:229], v253 offset:1024
    v_or_b32 v4, 0x0c0c, v4
    v_mfma_f32_16x16x32_bf16 v[60:63], a[216:219], a[216:219], v[60:63]
    s_mov_b32 s48, 0x00030003
    v_fmac_f32 v140, v56, v72
    v_fmac_f32 v141, v57, v73
    v_mfma_f32_16x16x32_bf16 v[60:63], a[220:223], a[220:223], v[60:63]
    s_waitcnt lgkmcnt(6)
    v_fmac_f32 v142, v58, v74
    v_fmac_f32 v143, v59, v75
    v_mfma_f32_16x16x32_bf16 v[76:79], v[86:89], v[88:91], 0
    s_mov_b32 s49, s48
    ds_read_b64 v[90:91], v255 offset:16160
    ds_read_b64 v[86:87], v255 offset:16160
    v_mfma_f32_16x16x32_bf16 v[48:51], a[224:227], a[224:227], 0
    v_cndmask_b32_e64 v232, 0, v0, s[48:49]
    v_mfma_f32_16x16x32_bf16 v[48:51], a[228:231], a[228:231], v[48:51]
    s_lshl_b64 s[48:49], s[48:49], 2
    v_cndmask_b32_e64 v233, 0, v0, s[48:49]
    v_mfma_f32_16x16x32_bf16 v[48:51], a[232:235], a[232:235], v[48:51]
    s_lshl_b64 s[48:49], s[48:49], 2
    v_fmac_f32 v140, v60, v76
    v_fmac_f32 v141, v61, v77
    v_mfma_f32_16x16x32_bf16 v[48:51], a[236:239], a[236:239], v[48:51]
    s_waitcnt lgkmcnt(4)
    v_fmac_f32 v142, v62, v78
    v_fmac_f32 v143, v63, v79
    v_mfma_f32_16x16x32_bf16 v[64:67], v[80:83], v[82:85], 0
    buffer_load_dwordx4 v[144:147], v5, s[36:39], s91 offen offset:0 sc1
    v_mfma_f32_16x16x32_bf16 v[52:55], a[240:243], a[240:243], 0
    ds_read_b64 v[84:85], v255 offset:19392
    ds_read_b64 v[80:81], v255 offset:19392
    v_mfma_f32_16x16x32_bf16 v[52:55], a[244:247], a[244:247], v[52:55]
    v_cndmask_b32_e64 v234, 0, v0, s[48:49]
    v_mfma_f32_16x16x32_bf16 v[52:55], a[248:251], a[248:251], v[52:55]
    buffer_load_dwordx4 v[148:151], v5, s[36:39], s91 offen offset:1024 sc1
    v_mfma_f32_16x16x32_bf16 v[52:55], a[252:255], a[252:255], v[52:55]
    s_waitcnt lgkmcnt(2)
    v_fmac_f32 v140, v48, v64
    v_fmac_f32 v141, v49, v65
    v_mfma_f32_16x16x32_bf16 v[68:71], v[86:89], v[88:91], 0
    s_lshl_b64 s[48:49], s[48:49], 2
    ds_read_b64 v[90:91], v255 offset:3200
    ds_read_b64 v[86:87], v255 offset:32
    v_mfma_f32_16x16x32_bf16 v[56:59], v[96:99], v[96:99], 0
    v_fmac_f32 v142, v50, v66
    v_fmac_f32 v143, v51, v67
    v_mfma_f32_16x16x32_bf16 v[56:59], v[100:103], v[100:103], v[56:59]
    v_cndmask_b32_e64 v235, 0, v0, s[48:49]
    v_mfma_f32_16x16x32_bf16 v[56:59], v[104:107], v[104:107], v[56:59]
    s_lshl_b64 s[48:49], s[48:49], 2
    v_fmac_f32 v140, v52, v68
    v_fmac_f32 v141, v53, v69
    v_mfma_f32_16x16x32_bf16 v[56:59], v[108:111], v[108:111], v[56:59]
    s_waitcnt lgkmcnt(2)
    v_fmac_f32 v142, v54, v70
    v_fmac_f32 v143, v55, v71
    v_mfma_f32_16x16x32_bf16 v[72:75], v[80:83], v[82:85], 0
    ds_read_b64 v[84:85], v255 offset:6432
    ds_read_b64 v[80:81], v255 offset:3264
    v_mfma_f32_16x16x32_bf16 v[60:63], a[160:163], a[176:179], 0
    v_cndmask_b32_e64 v236, 0, v0, s[48:49]
    v_mfma_f32_16x16x32_bf16 v[60:63], a[164:167], a[180:183], v[60:63]
    s_lshl_b64 s[48:49], s[48:49], 2
    v_cndmask_b32_e64 v237, 0, v0, s[48:49]
    v_mfma_f32_16x16x32_bf16 v[60:63], a[168:171], a[184:187], v[60:63]
    s_lshl_b64 s[48:49], s[48:49], 2
    v_fmac_f32 v140, v56, v72
    v_fmac_f32 v141, v57, v73
    v_mfma_f32_16x16x32_bf16 v[60:63], a[172:175], a[188:191], v[60:63]
    s_waitcnt lgkmcnt(2)
    v_fmac_f32 v142, v58, v74
    v_fmac_f32 v143, v59, v75
    v_mfma_f32_16x16x32_bf16 v[76:79], v[86:89], v[88:91], 0
    ds_read_b64 v[90:91], v255 offset:9664
    ds_read_b64 v[86:87], v255 offset:6496
    v_mfma_f32_16x16x32_bf16 v[48:51], a[176:179], a[192:195], 0
    v_cndmask_b32_e64 v238, 0, v0, s[48:49]
    v_mfma_f32_16x16x32_bf16 v[48:51], a[180:183], a[196:199], v[48:51]
    s_lshl_b64 s[48:49], s[48:49], 2
    v_cndmask_b32_e64 v239, 0, v0, s[48:49]
    v_mfma_f32_16x16x32_bf16 v[48:51], a[184:187], a[200:203], v[48:51]
    v_mul_f32 v136, v60, v76
    v_mul_f32 v137, v61, v77
    v_mfma_f32_16x16x32_bf16 v[48:51], a[188:191], a[204:207], v[48:51]
    s_waitcnt lgkmcnt(2)
    v_mul_f32 v138, v62, v78
    v_mul_f32 v139, v63, v79
    v_mfma_f32_16x16x32_bf16 v[64:67], v[80:83], v[82:85], 0
    ds_read_b64 v[84:85], v255 offset:12896
    ds_read_b64 v[80:81], v255 offset:9728
    v_mfma_f32_16x16x32_bf16 v[52:55], a[192:195], a[208:211], 0
    v_perm_b32 v226, v224, v224, v4
    v_perm_b32 v227, v225, v225, v4
    v_mfma_f32_16x16x32_bf16 v[52:55], a[196:199], a[212:215], v[52:55]
    v_perm_b32 v224, v224, v224, v4
    v_perm_b32 v225, v225, v225, v4
    v_mfma_f32_16x16x32_bf16 v[52:55], a[200:203], a[216:219], v[52:55]
    v_fmac_f32 v136, v48, v64
    v_fmac_f32 v137, v49, v65
    v_mfma_f32_16x16x32_bf16 v[52:55], a[204:207], a[220:223], v[52:55]
    s_waitcnt lgkmcnt(2)
    v_fmac_f32 v138, v50, v66
    v_fmac_f32 v139, v51, v67
    v_mfma_f32_16x16x32_bf16 v[68:71], v[86:89], v[88:91], 0
    ds_read_b64 v[90:91], v255 offset:16128
    ds_read_b64 v[86:87], v255 offset:12960
    v_mfma_f32_16x16x32_bf16 v[56:59], a[208:211], a[224:227], 0
    v_perm_b32 v228, v228, v228, v4
    v_perm_b32 v229, v229, v229, v4
    v_mfma_f32_16x16x32_bf16 v[56:59], a[212:215], a[228:231], v[56:59]
    v_mfma_f32_16x16x32_bf16 v[56:59], a[216:219], a[232:235], v[56:59]
    v_fmac_f32 v136, v52, v68
    v_fmac_f32 v137, v53, v69
    v_mfma_f32_16x16x32_bf16 v[56:59], a[220:223], a[236:239], v[56:59]
    s_waitcnt lgkmcnt(2)
    v_fmac_f32 v138, v54, v70
    v_fmac_f32 v139, v55, v71
    v_mfma_f32_16x16x32_bf16 v[72:75], v[80:83], v[82:85], 0
    ds_read_b64 v[84:85], v255 offset:19360
    ds_read_b64 v[80:81], v255 offset:16192
    v_mfma_f32_16x16x32_bf16 v[60:63], a[224:227], a[240:243], 0
    v_mfma_f32_16x16x32_bf16 v[60:63], a[228:231], a[244:247], v[60:63]
    v_mfma_f32_16x16x32_bf16 v[60:63], a[232:235], a[248:251], v[60:63]
    v_fmac_f32 v136, v56, v72
    v_fmac_f32 v137, v57, v73
    v_mfma_f32_16x16x32_bf16 v[60:63], a[236:239], a[252:255], v[60:63]
    s_waitcnt lgkmcnt(2)
    v_fmac_f32 v138, v58, v74
    v_fmac_f32 v139, v59, v75
    v_mfma_f32_16x16x32_bf16 v[76:79], v[86:89], v[88:91], 0
    ds_read_b64 v[90:91], v255 offset:192
    ds_read_b64 v[86:87], v255 offset:19200
    v_mfma_f32_16x16x32_bf16 v[48:51], a[240:243], v[96:99], 0
    v_mfma_f32_16x16x32_bf16 v[48:51], a[244:247], v[100:103], v[48:51]
    v_mfma_f32_16x16x32_bf16 v[48:51], a[248:251], v[104:107], v[48:51]
    v_fmac_f32 v136, v60, v76
    v_fmac_f32 v137, v61, v77
    v_mfma_f32_16x16x32_bf16 v[48:51], a[252:255], v[108:111], v[48:51]
    s_waitcnt lgkmcnt(2)
    v_fmac_f32 v138, v62, v78
    v_fmac_f32 v139, v63, v79
    v_mfma_f32_16x16x32_bf16 v[64:67], v[80:83], v[82:85], 0
    ds_read_b64 v[84:85], v255 offset:6400
    ds_read_b64 v[80:81], v255 offset:64
    v_mfma_f32_16x16x32_bf16 v[52:55], v[96:99], a[160:163], 0
    v_mfma_f32_16x16x32_bf16 v[52:55], v[100:103], a[164:167], v[52:55]
    v_mfma_f32_16x16x32_bf16 v[52:55], v[104:107], a[168:171], v[52:55]
    v_fmac_f32 v136, v48, v64
    v_fmac_f32 v137, v49, v65
    v_mfma_f32_16x16x32_bf16 v[52:55], v[108:111], a[172:175], v[52:55]
    s_waitcnt lgkmcnt(2)
    v_fmac_f32 v138, v50, v66
    v_fmac_f32 v139, v51, v67
    v_mfma_f32_16x16x32_bf16 v[68:71], v[86:89], v[88:91], 0
    ds_read_b64 v[90:91], v255 offset:9632
    ds_read_b64 v[86:87], v255 offset:3296
    v_mfma_f32_16x16x32_bf16 v[56:59], a[160:163], a[192:195], 0
    v_mfma_f32_16x16x32_bf16 v[56:59], a[164:167], a[196:199], v[56:59]
    s_waitcnt vmcnt(1)
    v_mfma_f32_16x16x32_bf16 v[160:163], v[232:235], v[144:147], v[224:227]
    s_waitcnt vmcnt(0)
    v_fmac_f32 v136, v52, v68
    v_fmac_f32 v137, v53, v69
    v_mfma_f32_16x16x32_bf16 v[160:163], v[236:239], v[148:151], v[160:163]
    v_fmac_f32 v138, v54, v70
    v_fmac_f32 v139, v55, v71
    v_mfma_f32_16x16x32_bf16 v[56:59], a[168:171], a[200:203], v[56:59]
    v_mfma_f32_16x16x32_bf16 v[56:59], a[172:175], a[204:207], v[56:59]
    s_waitcnt lgkmcnt(2)
    v_mfma_f32_16x16x32_bf16 v[72:75], v[80:83], v[82:85], 0
    ds_read_b64 v[84:85], v255 offset:12864
    ds_read_b64 v[80:81], v255 offset:6528
    v_mfma_f32_16x16x32_bf16 v[60:63], a[176:179], a[208:211], 0
    v_cmp_u_f32 vcc, v160, v160
    v_mfma_f32_16x16x32_bf16 v[60:63], a[180:183], a[212:215], v[60:63]
    s_cbranch_vccnz L_x0
L_x0b:
    v_mfma_f32_16x16x32_bf16 v[60:63], a[184:187], a[216:219], v[60:63]
    v_fmac_f32 v136, v56, v72
    v_fmac_f32 v137, v57, v73
    v_mfma_f32_16x16x32_bf16 v[60:63], a[188:191], a[220:223], v[60:63]
    s_waitcnt lgkmcnt(2)
    v_fmac_f32 v138, v58, v74
    v_fmac_f32 v139, v59, v75
    v_mfma_f32_16x16x32_bf16 v[76:79], v[86:89], v[88:91], 0
    ds_read_b64 v[90:91], v255 offset:16096
    ds_read_b64 v[86:87], v255 offset:9760
    v_mfma_f32_16x16x32_bf16 v[48:51], a[192:195], a[224:227], 0
    buffer_load_dwordx4 v[152:155], v5, s[36:39], s91 offen offset:2048 sc1
    v_mfma_f32_16x16x32_bf16 v[48:51], a[196:199], a[228:231], v[48:51]
    v_mul_f32 v164, v160, v160
    v_mul_f32 v165, v161, v161
    v_mfma_f32_16x16x32_bf16 v[48:51], a[200:203], a[232:235], v[48:51]
    v_fmac_f32 v136, v60, v76
    v_fmac_f32 v137, v61, v77
    v_mfma_f32_16x16x32_bf16 v[48:51], a[204:207], a[236:239], v[48:51]
    s_waitcnt lgkmcnt(2)
    buffer_load_dwordx4 v[156:159], v5, s[36:39], s91 offen offset:3072 sc1
    v_mfma_f32_16x16x32_bf16 v[64:67], v[80:83], v[82:85], 0
    ds_read_b64 v[84:85], v255 offset:19328
    ds_read_b64 v[80:81], v255 offset:12992
    v_mfma_f32_16x16x32_bf16 v[52:55], a[208:211], a[240:243], 0
    v_fmac_f32 v138, v62, v78
    v_fmac_f32 v139, v63, v79
    v_mfma_f32_16x16x32_bf16 v[52:55], a[212:215], a[244:247], v[52:55]
    v_mul_f32 v166, v162, v162
    v_mul_f32 v167, v163, v163
    v_mfma_f32_16x16x32_bf16 v[52:55], a[216:219], a[248:251], v[52:55]
    v_fmac_f32 v136, v48, v64
    v_fmac_f32 v137, v49, v65
    v_mfma_f32_16x16x32_bf16 v[52:55], a[220:223], a[252:255], v[52:55]
    s_waitcnt lgkmcnt(2)
    v_fmac_f32 v138, v50, v66
    v_fmac_f32 v139, v51, v67
    v_mfma_f32_16x16x32_bf16 v[68:71], v[86:89], v[88:91], 0
    ds_read_b64 v[90:91], v255 offset:160
    ds_read_b64 v[86:87], v255 offset:16000
    v_mfma_f32_16x16x32_bf16 v[56:59], a[224:227], v[96:99], 0
    v_fma_f32 v164, v164, s9, v9
    v_fma_f32 v165, v165, s9, v9
    v_mfma_f32_16x16x32_bf16 v[56:59], a[228:231], v[100:103], v[56:59]
    v_fma_f32 v166, v166, s9, v9
    v_fma_f32 v167, v167, s9, v9
    v_mfma_f32_16x16x32_bf16 v[56:59], a[232:235], v[104:107], v[56:59]
    v_fmac_f32 v136, v52, v68
    v_fmac_f32 v137, v53, v69
    v_mfma_f32_16x16x32_bf16 v[56:59], a[236:239], v[108:111], v[56:59]
    s_waitcnt lgkmcnt(2)
    v_fmac_f32 v138, v54, v70
    v_fmac_f32 v139, v55, v71
    v_mfma_f32_16x16x32_bf16 v[72:75], v[80:83], v[82:85], 0
    ds_read_b64 v[84:85], v255 offset:3392
    ds_read_b64 v[80:81], v255 offset:19232
    v_mfma_f32_16x16x32_bf16 v[60:63], a[240:243], a[160:163], 0
    v_mul_f32 v164, v164, v160
    v_mul_f32 v165, v165, v161
    v_mfma_f32_16x16x32_bf16 v[60:63], a[244:247], a[164:167], v[60:63]
    v_mul_f32 v166, v166, v162
    v_mul_f32 v167, v167, v163
    v_mfma_f32_16x16x32_bf16 v[60:63], a[248:251], a[168:171], v[60:63]
    v_fmac_f32 v136, v56, v72
    v_fmac_f32 v137, v57, v73
    v_mfma_f32_16x16x32_bf16 v[60:63], a[252:255], a[172:175], v[60:63]
    s_waitcnt lgkmcnt(2)
    v_fmac_f32 v138, v58, v74
    v_fmac_f32 v139, v59, v75
    v_mfma_f32_16x16x32_bf16 v[76:79], v[86:89], v[88:91], 0
    ds_read_b64 v[90:91], v255 offset:9600
    ds_read_b64 v[86:87], v255 offset:96
    v_mfma_f32_16x16x32_bf16 v[48:51], v[96:99], a[176:179], 0
    v_exp_f32 v164, v164
    v_mfma_f32_16x16x32_bf16 v[48:51], v[100:103], a[180:183], v[48:51]
    v_exp_f32 v165, v165
    v_mfma_f32_16x16x32_bf16 v[48:51], v[104:107], a[184:187], v[48:51]
    v_fmac_f32 v136, v60, v76
    v_fmac_f32 v137, v61, v77
    v_mfma_f32_16x16x32_bf16 v[48:51], v[108:111], a[188:191], v[48:51]
    s_waitcnt lgkmcnt(2)
    v_fmac_f32 v138, v62, v78
    v_fmac_f32 v139, v63, v79
    v_mfma_f32_16x16x32_bf16 v[64:67], v[80:83], v[82:85], 0
    ds_read_b64 v[84:85], v255 offset:12832
    ds_read_b64 v[80:81], v255 offset:3328
    v_mfma_f32_16x16x32_bf16 v[52:55], a[160:163], a[208:211], 0
    v_exp_f32 v166, v166
    v_mfma_f32_16x16x32_bf16 v[52:55], a[164:167], a[212:215], v[52:55]
    v_exp_f32 v167, v167
    v_mfma_f32_16x16x32_bf16 v[52:55], a[168:171], a[216:219], v[52:55]
    v_fmac_f32 v136, v48, v64
    v_fmac_f32 v137, v49, v65
    v_mfma_f32_16x16x32_bf16 v[52:55], a[172:175], a[220:223], v[52:55]
    s_waitcnt lgkmcnt(2)
    v_fmac_f32 v138, v50, v66
    v_fmac_f32 v139, v51, v67
    v_mfma_f32_16x16x32_bf16 v[68:71], v[86:89], v[88:91], 0
    ds_read_b64 v[90:91], v255 offset:16064
    ds_read_b64 v[86:87], v255 offset:6560
    v_mfma_f32_16x16x32_bf16 v[56:59], a[176:179], a[224:227], 0
    v_mul_f32 v160, v160, v228
    v_mul_f32 v161, v161, v229
    v_mfma_f32_16x16x32_bf16 v[56:59], a[180:183], a[228:231], v[56:59]
    v_mul_f32 v162, v162, v228
    v_mul_f32 v163, v163, v229
    v_mfma_f32_16x16x32_bf16 v[56:59], a[184:187], a[232:235], v[56:59]
    v_fmac_f32 v136, v52, v68
    v_fmac_f32 v137, v53, v69
    v_mfma_f32_16x16x32_bf16 v[56:59], a[188:191], a[236:239], v[56:59]
    s_waitcnt lgkmcnt(2)
    v_fmac_f32 v138, v54, v70
    v_fmac_f32 v139, v55, v71
    v_mfma_f32_16x16x32_bf16 v[72:75], v[80:83], v[82:85], 0
    ds_read_b64 v[84:85], v255 offset:19296
    ds_read_b64 v[80:81], v255 offset:9792
    v_mfma_f32_16x16x32_bf16 v[60:63], a[192:195], a[240:243], 0
    v_add_f32 v164, 1.0, v164
    v_add_f32 v165, 1.0, v165
    v_mfma_f32_16x16x32_bf16 v[60:63], a[196:199], a[244:247], v[60:63]
    v_add_f32 v166, 1.0, v166
    v_add_f32 v167, 1.0, v167
    v_mfma_f32_16x16x32_bf16 v[60:63], a[200:203], a[248:251], v[60:63]
    v_fmac_f32 v136, v56, v72
    v_fmac_f32 v137, v57, v73
    v_mfma_f32_16x16x32_bf16 v[60:63], a[204:207], a[252:255], v[60:63]
    s_waitcnt lgkmcnt(2)
    v_fmac_f32 v138, v58, v74
    v_fmac_f32 v139, v59, v75
    v_mfma_f32_16x16x32_bf16 v[76:79], v[86:89], v[88:91], 0
    ds_read_b64 v[90:91], v255 offset:128
    ds_read_b64 v[86:87], v255 offset:12800
    v_mfma_f32_16x16x32_bf16 v[48:51], a[208:211], v[96:99], 0
    v_rcp_f32 v164, v164
    v_mfma_f32_16x16x32_bf16 v[48:51], a[212:215], v[100:103], v[48:51]
    v_rcp_f32 v165, v165
    v_mfma_f32_16x16x32_bf16 v[48:51], a[216:219], v[104:107], v[48:51]
    v_fmac_f32 v136, v60, v76
    v_fmac_f32 v137, v61, v77
    v_mfma_f32_16x16x32_bf16 v[48:51], a[220:223], v[108:111], v[48:51]
    s_waitcnt lgkmcnt(2)
    v_fmac_f32 v138, v62, v78
    v_fmac_f32 v139, v63, v79
    v_mfma_f32_16x16x32_bf16 v[64:67], v[80:83], v[82:85], 0
    ds_read_b64 v[84:85], v255 offset:3360
    ds_read_b64 v[80:81], v255 offset:16032
    v_mfma_f32_16x16x32_bf16 v[52:55], a[224:227], a[160:163], 0
    v_rcp_f32 v166, v166
    v_mfma_f32_16x16x32_bf16 v[52:55], a[228:231], a[164:167], v[52:55]
    v_rcp_f32 v167, v167
    v_mfma_f32_16x16x32_bf16 v[52:55], a[232:235], a[168:171], v[52:55]
    v_fmac_f32 v136, v48, v64
    v_fmac_f32 v137, v49, v65
    s_waitcnt vmcnt(1)
    v_mfma_f32_16x16x32_bf16 v[168:171], v[232:235], v[152:155], v[224:227]
    s_waitcnt vmcnt(0)
    v_fmac_f32 v138, v50, v66
    v_fmac_f32 v139, v51, v67
    v_mfma_f32_16x16x32_bf16 v[168:171], v[236:239], v[156:159], v[168:171]
    v_mul_f32 v160, v160, v164
    v_mul_f32 v162, v162, v166
    v_mfma_f32_16x16x32_bf16 v[52:55], a[236:239], a[172:175], v[52:55]
    s_waitcnt lgkmcnt(2)
    v_fmac_f32 v160, v161, v165
    v_fmac_f32 v162, v163, v167
    v_mfma_f32_16x16x32_bf16 v[68:71], v[86:89], v[88:91], 0
    ds_read_b64 v[90:91], v255 offset:6592
    ds_read_b64 v[86:87], v255 offset:19264
    v_mfma_f32_16x16x32_bf16 v[56:59], a[240:243], a[176:179], 0
    v_add_f32_dpp v160, v160, v160 row_ror:8 row_mask:0xf bank_mask:0x3
    v_cmp_u_f32 vcc, v168, v168
    v_mfma_f32_16x16x32_bf16 v[56:59], a[244:247], a[180:183], v[56:59]
    s_cbranch_vccnz L_x1
L_x1b:
    v_mul_f32 v172, v168, v168
    v_mfma_f32_16x16x32_bf16 v[56:59], a[248:251], a[184:187], v[56:59]
    v_fmac_f32 v136, v52, v68
    v_fmac_f32 v137, v53, v69
    v_mul_f32 v173, v169, v169
    v_mfma_f32_16x16x32_bf16 v[56:59], a[252:255], a[188:191], v[56:59]
    s_waitcnt lgkmcnt(2)
    v_fmac_f32 v138, v54, v70
    v_fmac_f32 v139, v55, v71
    v_mul_f32 v174, v170, v170
    v_mfma_f32_16x16x32_bf16 v[72:75], v[80:83], v[82:85], 0
    v_add_f32_dpp v160, v162, v162 row_ror:8 row_mask:0xf bank_mask:0xc
    v_mul_f32 v175, v171, v171
    v_fma_f32 v172, v172, s9, v9
    v_mfma_f32_16x16x32_bf16 v[60:63], v[96:99], a[192:195], 0
    v_fma_f32 v173, v173, s9, v9
    v_fma_f32 v174, v174, s9, v9
    v_fma_f32 v175, v175, s9, v9
    v_mfma_f32_16x16x32_bf16 v[60:63], v[100:103], a[196:199], v[60:63]
    v_add_f32_dpp v230, v160, v160 row_half_mirror row_mask:0xf bank_mask:0x5
    v_mul_f32 v172, v172, v168
    v_mul_f32 v173, v173, v169
    v_mfma_f32_16x16x32_bf16 v[60:63], v[104:107], a[200:203], v[60:63]
    v_fmac_f32 v136, v56, v72
    v_fmac_f32 v137, v57, v73
    v_mul_f32 v174, v174, v170
    v_mfma_f32_16x16x32_bf16 v[60:63], v[108:111], a[204:207], v[60:63]
    s_waitcnt lgkmcnt(0)
    v_fmac_f32 v138, v58, v74
    v_fmac_f32 v139, v59, v75
    v_mul_f32 v175, v175, v171
    v_mfma_f32_16x16x32_bf16 v[76:79], v[86:89], v[88:91], 0
    v_exp_f32 v172, v172
    v_exp_f32 v173, v173
    v_exp_f32 v174, v174
    v_exp_f32 v175, v175
    v_mul_f32 v168, v168, v228
    v_mul_f32 v169, v169, v229
    v_mul_f32 v170, v170, v228
    v_mul_f32 v171, v171, v229
    v_add_f32 v172, 1.0, v172
    v_add_f32 v173, 1.0, v173
    v_add_f32 v174, 1.0, v174
    v_add_f32 v175, 1.0, v175
    v_rcp_f32 v172, v172
    v_rcp_f32 v173, v173
    v_rcp_f32 v174, v174
    v_rcp_f32 v175, v175
    v_mul_f32 v168, v168, v172
    v_mul_f32 v170, v170, v174
    v_fmac_f32 v168, v169, v173
    v_fmac_f32 v170, v171, v175
    v_fmac_f32 v136, v60, v76
    v_add_f32_dpp v168, v168, v168 row_ror:8 row_mask:0xf bank_mask:0x3
    v_fmac_f32 v137, v61, v77
    v_fmac_f32 v138, v62, v78
    v_add_f32_dpp v168, v170, v170 row_ror:8 row_mask:0xf bank_mask:0xc
    v_fmac_f32 v139, v63, v79
    v_fma_f32 v136, v140, 0.5, v136
    v_add_f32_dpp v230, v168, v168 row_half_mirror row_mask:0xf bank_mask:0xa
    v_fma_f32 v137, v141, 0.5, v137
    v_fma_f32 v138, v142, 0.5, v138
    v_add_f32_dpp v230, v230, v230 quad_perm:[1,0,3,2] row_mask:0xf bank_mask:0xf
    v_fma_f32 v139, v143, 0.5, v139
    v_add_f32 v136, v136, v137
    v_add_f32_dpp v230, v230, v230 quad_perm:[2,3,0,1] row_mask:0xf bank_mask:0xf
    ds_write_b32 v254, v230
    v_add_f32 v138, v138, v139
    v_add_f32 v136, v136, v138
    s_nop 1
    v_add_f32_dpp v136, v136, v136 row_shr:1 row_mask:0xf bank_mask:0xf
    s_waitcnt lgkmcnt(0)
    s_barrier
    ds_read_b64 v[248:249], v252
    v_add_f32_dpp v136, v136, v136 row_shr:2 row_mask:0xf bank_mask:0xf
    s_nop 1
    v_add_f32_dpp v136, v136, v136 row_shr:4 row_mask:0xf bank_mask:0xf
    s_nop 1
    v_add_f32_dpp v136, v136, v136 row_shr:8 row_mask:0xf bank_mask:0xf
    s_nop 1
    v_add_f32_dpp v136, v136, v136 row_bcast:15 row_mask:0xa bank_mask:0xf
    s_nop 1
    v_add_f32_dpp v136, v136, v136 row_bcast:31 row_mask:0xc bank_mask:0xf
    v_mov_b32 v6, s8
    v_cvt_pk_bf16_f32 v7, v136, v136
    v_and_b32 v136, s11, v7
    s_waitcnt lgkmcnt(0)
    v_add_f32 v10, v248, v249
    s_nop 1
    v_add_f32_dpp v10, v10, v10 quad_perm:[1,0,3,2] row_mask:0xf bank_mask:0xf
    s_nop 1
    v_add_f32_dpp v10, v10, v10 quad_perm:[2,3,0,1] row_mask:0xf bank_mask:0xf
    s_nop 1
    v_add_f32_dpp v10, v10, v10 row_half_mirror row_mask:0xf bank_mask:0xf
    v_cvt_pk_bf16_f32 v7, v10, v10
    v_and_b32 v10, s11, v7
    v_add_f32 v10, v10, v244
    v_cvt_pk_bf16_f32 v7, v10, v10
    v_and_b32 v10, s11, v7
    v_add_f32 v10, v10, v136
    v_cvt_pk_bf16_f32 v10, v10, v10
    s_mov_b32 exec_lo, 0
    s_mov_b32 exec_hi, 0x80000000
    global_store_short v6, v10, s[58:59]
L_tail:
L_done:
    s_endpgm
L_pgq:
    s_branch L_pgb
L_x1:
    s_nop 4
    v_max3_i32 v172, v152, v153, v154
    v_max3_i32 v173, v155, v156, v157
    v_max3_i32 v172, v172, v158, v159
    v_max_i32 v172, v172, v173
    v_cmp_eq_u32 vcc, s12, v172
    s_sub_u32 s97, s97, 1
    s_cbranch_vccz L_x1c
    s_mov_b64 exec, vcc
    buffer_load_dwordx4 v[152:155], v5, s[36:39], s91 offen offset:2048 sc1
    buffer_load_dwordx4 v[156:159], v5, s[36:39], s91 offen offset:3072 sc1
    s_mov_b64 exec, -1
    s_waitcnt vmcnt(0)
    s_cbranch_scc0 L_x1
L_x1c:
    v_mfma_f32_16x16x32_bf16 v[168:171], v[232:235], v[152:155], v[224:227]
    v_mfma_f32_16x16x32_bf16 v[168:171], v[236:239], v[156:159], v[168:171]
    s_nop 7
    s_branch L_x1b
L_x0:
    s_nop 4
    v_max3_i32 v164, v144, v145, v146
    v_max3_i32 v165, v147, v148, v149
    v_max3_i32 v164, v164, v150, v151
    v_max_i32 v164, v164, v165
    v_cmp_eq_u32 vcc, s12, v164
    s_sub_u32 s97, s97, 1
    s_cbranch_vccz L_x0c
    s_mov_b64 exec, vcc
    buffer_load_dwordx4 v[144:147], v5, s[36:39], s91 offen offset:0 sc1
    buffer_load_dwordx4 v[148:151], v5, s[36:39], s91 offen offset:1024 sc1
    s_mov_b64 exec, -1
    s_waitcnt vmcnt(0)
    s_cbranch_scc0 L_x0
L_x0c:
    v_mfma_f32_16x16x32_bf16 v[160:163], v[232:235], v[144:147], v[224:227]
    v_mfma_f32_16x16x32_bf16 v[160:163], v[236:239], v[148:151], v[160:163]
    s_nop 7
    s_branch L_x0b
L_r1:
    s_nop 4
    buffer_load_dword v249, v248, s[36:39], s7 offen sc1
    s_waitcnt vmcnt(0)
    v_cmp_ne_u32 vcc, s12, v249
    s_sub_u32 s97, s97, 1
    s_cbranch_vccz L_r1b
    s_cbranch_scc0 L_r1
    s_branch L_r1b
L_end:
.section .rodata,"a"
.p2align 6
.amdhsa_kernel standalone__deep_cross_pnn__recsys_kernel
  .amdhsa_next_free_vgpr 512
  .amdhsa_next_free_sgpr 102
  .amdhsa_accum_offset 256
  .amdhsa_group_segment_fixed_size 0
  .amdhsa_kernarg_size 80
  .amdhsa_user_sgpr_count 2
  .amdhsa_user_sgpr_kernarg_segment_ptr 1
  .amdhsa_system_sgpr_workgroup_id_x 1
.end_amdhsa_kernel
```
